```python
import torch

def _softmax(x, axis=-1):
    return torch.softmax(x, dim=axis)
def _gelu(x):
    return torch.nn.functional.gelu(x, approximate="tanh")
def _silu(x):
    return torch.nn.functional.silu(x)
def _sigmoid(x):
    return torch.sigmoid(x)
def _layernorm(x, axis=-1, eps=1e-5):
    m = x.mean(dim=axis, keepdim=True)
    v = x.var(dim=axis, keepdim=True, unbiased=False)
    return (x - m) / torch.sqrt(v + eps)
def _scatter_add(tgt, idx, src, axis=0):
    return tgt.clone().index_add_(axis, idx, src)
def _segment_sum(src, seg, n):
    out = torch.zeros((n,) + src.shape[1:], dtype=src.dtype)
    return out.index_add_(0, seg, src)
def _pad(x, pw):
    flat = tuple(v for pair in reversed(pw) for v in pair)
    return torch.nn.functional.pad(x, flat)

kernel_name = 'standalone__sliding_block__prompt'

def setup_inputs():

    _w = (lambda a: (lambda t: t.to(torch.bfloat16) if t.is_floating_point() else t)(torch.as_tensor(a)))
    B, S, D = 1, 2048, 1024
    return {
        "x": _w((lambda *s: torch.randn(*s, dtype=torch.bfloat16) * 0.2)(B, S, D)),
        "wqkv": _w((lambda *s: torch.randn(*s, dtype=torch.bfloat16) * 0.2)(D, 3 * D)),
        "wo": _w((lambda *s: torch.randn(*s, dtype=torch.bfloat16) * 0.05)(D, D)),
    }

def reference(x, wqkv, wo):
    B, S, D = x.shape
    H = 32; Dh = D // H; W = 256
    qkv = (lambda x, *d: x.permute(*d))((x @ wqkv).reshape(B, S, 3, H, Dh), 2, 0, 3, 1, 4)
    q, k, v = qkv[0], qkv[1], qkv[2]
    scores = torch.einsum("bhqd,bhkd->bhqk", q, k) * (Dh ** -0.5)
    idx = torch.arange(S)
    mask = (idx[:, None] - idx[None, :] >= 0) & (idx[:, None] - idx[None, :] < W)
    scores = torch.where(mask[None, None], scores, -1e9)
    p = _softmax(scores, axis=-1)
    o = torch.einsum("bhqk,bhkd->bhqd", p, v)
    return (lambda x, *d: x.permute(*d))(o, 0, 2, 1, 3).reshape(B, S, D) @ wo
```

```asm
; @launch grid=(256,1,1) block=(512,1,1) lds=163840
.amdgcn_target "amdgcn-amd-amdhsa--gfx950"
.text
.globl standalone__sliding_block__prompt_kernel
.p2align 8
.type standalone__sliding_block__prompt_kernel,@function
standalone__sliding_block__prompt_kernel:
    s_cmp_ge_u32 s2, 256
    s_cbranch_scc1 L_END
    s_load_dwordx8 s[4:11], s[0:1], 0
    s_load_dwordx4 s[40:43], s[0:1], 32
    s_getpc_b64 s[96:97]
L_PC:
    v_lshlrev_b32 v2, 6, v0
    v_min_u32 v2, L_END-L_PC, v2
    global_load_dword v31, v2, s[96:97]
    v_lshrrev_b32 v1, 6, v0
    s_nop 0
    v_readfirstlane_b32 s24, v1
    v_and_b32 v0, 63, v0
    s_and_b32 s27, s2, 7
    s_lshr_b32 s28, s2, 3
    s_and_b32 s25, s27, 1
    s_lshl_b32 s25, s25, 3
    s_and_b32 s29, s28, 7
    s_add_u32 s25, s25, s29
    s_lshr_b32 s26, s27, 1
    s_lshl_b32 s26, s26, 2
    s_lshr_b32 s29, s28, 3
    s_add_u32 s26, s26, s29
    v_lshlrev_b32 v1, 4, v0
    s_cmp_lt_u32 s24, 4
    s_cbranch_scc1 L_KV
    s_sub_u32 s30, s24, 4
    v_lshrrev_b32 v4, 3, v0
    v_and_b32 v5, 7, v0
    v_lshrrev_b32 v6, 4, v0
    s_and_b32 s31, s30, 1
    s_lshl_b32 s32, s31, 2
    v_or_b32 v7, s32, v6
    v_xor_b32 v7, v7, v5
    v_lshlrev_b32 v7, 4, v7
    v_lshlrev_b32 v2, 11, v4
    v_add_u32 v2, v2, v7
    s_lshl_b32 s32, s25, 7
    s_lshl_b32 s33, s30, 3
    s_add_u32 s32, s32, s33
    s_lshl_b32 s32, s32, 11
    v_add_u32 v2, s32, v2
    v_and_b32 v7, 1, v6
    s_lshl_b32 s32, s31, 1
    v_or_b32 v7, s32, v7
    v_lshlrev_b32 v7, 1, v7
    v_xor_b32 v7, v7, v5
    v_lshlrev_b32 v7, 4, v7
    v_mul_u32_u24 v3, 0x1800, v4
    v_add_u32 v3, v3, v7
    s_mul_i32 s32, s30, 49152
    s_lshl_b32 s33, s26, 7
    s_add_u32 s32, s32, s33
    v_add_u32 v3, s32, v3
    s_lshl_b32 s34, s30, 10
    s_add_u32 s59, s25, s26
    s_waitcnt lgkmcnt(0)
    s_mov_b32 s12, s4
    s_mov_b32 s13, s5
    s_mov_b32 s14, 0x400000
    s_mov_b32 s15, 0x00020000
    s_mov_b32 s16, s6
    s_mov_b32 s17, s7
    s_mov_b32 s18, 0x600000
    s_mov_b32 s19, 0x00020000
    s_add_u32 s35, s59, 0
    s_and_b32 s35, s35, 15
    s_lshl_b32 s36, s35, 7
    s_mul_i32 s37, s35, 393216
    s_add_u32 m0, s34, 65536
    s_add_u32 s38, s36, 0
    buffer_load_dwordx4 v2, s[12:15], s38 offen lds
    s_add_u32 m0, s34, 69632
    s_add_u32 s38, s36, 65536
    buffer_load_dwordx4 v2, s[12:15], s38 offen lds
    s_add_u32 m0, s34, 73728
    s_add_u32 s38, s36, 131072
    buffer_load_dwordx4 v2, s[12:15], s38 offen lds
    s_add_u32 m0, s34, 77824
    s_add_u32 s38, s36, 196608
    buffer_load_dwordx4 v2, s[12:15], s38 offen lds
    s_add_u32 m0, s34, 0
    s_add_u32 s38, s37, 2048
    buffer_load_dwordx4 v3, s[16:19], s38 offen lds
    s_add_u32 m0, s34, 4096
    s_add_u32 s38, s37, 198656
    buffer_load_dwordx4 v3, s[16:19], s38 offen lds
    s_add_u32 m0, s34, 8192
    s_add_u32 s38, s37, 4096
    buffer_load_dwordx4 v3, s[16:19], s38 offen lds
    s_add_u32 m0, s34, 12288
    s_add_u32 s38, s37, 200704
    buffer_load_dwordx4 v3, s[16:19], s38 offen lds
    s_add_u32 s35, s59, 1
    s_and_b32 s35, s35, 15
    s_lshl_b32 s36, s35, 7
    s_mul_i32 s37, s35, 393216
    s_add_u32 m0, s34, 81920
    s_add_u32 s38, s36, 0
    buffer_load_dwordx4 v2, s[12:15], s38 offen lds
    s_add_u32 m0, s34, 86016
    s_add_u32 s38, s36, 65536
    buffer_load_dwordx4 v2, s[12:15], s38 offen lds
    s_add_u32 m0, s34, 90112
    s_add_u32 s38, s36, 131072
    buffer_load_dwordx4 v2, s[12:15], s38 offen lds
    s_add_u32 m0, s34, 94208
    s_add_u32 s38, s36, 196608
    buffer_load_dwordx4 v2, s[12:15], s38 offen lds
    s_add_u32 m0, s34, 16384
    s_add_u32 s38, s37, 2048
    buffer_load_dwordx4 v3, s[16:19], s38 offen lds
    s_add_u32 m0, s34, 20480
    s_add_u32 s38, s37, 198656
    buffer_load_dwordx4 v3, s[16:19], s38 offen lds
    s_add_u32 m0, s34, 24576
    s_add_u32 s38, s37, 4096
    buffer_load_dwordx4 v3, s[16:19], s38 offen lds
    s_add_u32 m0, s34, 28672
    s_add_u32 s38, s37, 200704
    buffer_load_dwordx4 v3, s[16:19], s38 offen lds
    s_mov_b32 s20, s42
    s_mov_b32 s21, s43
    s_mov_b32 s22, 0x4000000
    s_mov_b32 s23, 0x00020000
    s_mov_b32 s44, s8
    s_mov_b32 s45, s9
    s_mov_b32 s46, 0x200000
    s_mov_b32 s47, 0x00020000
    s_mov_b32 s48, s10
    s_mov_b32 s49, s11
    s_mov_b32 s50, 0x400000
    s_mov_b32 s51, 0x00020000
    s_mov_b32 s52, s40
    s_mov_b32 s53, s41
    s_mov_b32 s54, 0x100
    s_mov_b32 s55, 0x00020000
    v_and_b32 v14, 15, v0
    v_lshrrev_b32 v15, 4, v0
    v_lshrrev_b32 v16, 1, v14
    v_xor_b32 v16, v16, v15
    s_lshl_b32 s32, s30, 12
    v_lshlrev_b32 v17, 7, v14
    v_add_u32 v17, s32, v17
    v_add_u32 v17, 0x10000, v17
    v_xor_b32 v18, 0, v16
    v_lshlrev_b32 v18, 4, v18
    v_add_u32 v8, v17, v18
    v_xor_b32 v18, 4, v16
    v_lshlrev_b32 v18, 4, v18
    v_add_u32 v9, v17, v18
    v_lshrrev_b32 v17, 2, v14
    v_and_b32 v18, 3, v14
    v_lshlrev_b32 v19, 3, v15
    v_add_u32 v19, v19, v17
    v_lshlrev_b32 v19, 7, v19
    v_lshrrev_b32 v20, 1, v17
    v_and_b32 v21, 1, v15
    v_lshlrev_b32 v21, 1, v21
    v_or_b32 v20, v20, v21
    v_lshlrev_b32 v20, 5, v20
    v_lshlrev_b32 v18, 3, v18
    v_add3_u32 v19, v19, v20, v18
    v_xor_b32 v10, 0, v19
    v_xor_b32 v11, 32, v19
    v_xor_b32 v12, 64, v19
    v_xor_b32 v13, 96, v19
    v_add_u32 v24, 0x20000, v10
    v_add_u32 v25, 0x20000, v11
    v_add_u32 v26, 0x20000, v12
    v_add_u32 v27, 0x20000, v13
    v_mov_b32 v192, 0
    v_mov_b32 v193, 0
    v_mov_b32 v194, 0
    v_mov_b32 v195, 0
    v_mov_b32 v196, 0
    v_mov_b32 v197, 0
    v_mov_b32 v198, 0
    v_mov_b32 v199, 0
    v_mov_b32 v200, 0
    v_mov_b32 v201, 0
    v_mov_b32 v202, 0
    v_mov_b32 v203, 0
    v_mov_b32 v204, 0
    v_mov_b32 v205, 0
    v_mov_b32 v206, 0
    v_mov_b32 v207, 0
    v_mov_b32 v208, 0
    v_mov_b32 v209, 0
    v_mov_b32 v210, 0
    v_mov_b32 v211, 0
    v_mov_b32 v212, 0
    v_mov_b32 v213, 0
    v_mov_b32 v214, 0
    v_mov_b32 v215, 0
    v_mov_b32 v216, 0
    v_mov_b32 v217, 0
    v_mov_b32 v218, 0
    v_mov_b32 v219, 0
    v_mov_b32 v220, 0
    v_mov_b32 v221, 0
    v_mov_b32 v222, 0
    v_mov_b32 v223, 0
    s_waitcnt vmcnt(8)
    s_barrier
    s_add_u32 s35, s59, 2
    s_and_b32 s35, s35, 15
    s_lshl_b32 s36, s35, 7
    s_mul_i32 s37, s35, 393216
    s_add_u32 m0, s34, 98304
    s_add_u32 s38, s36, 0
    buffer_load_dwordx4 v2, s[12:15], s38 offen lds
    s_add_u32 m0, s34, 102400
    s_add_u32 s38, s36, 65536
    buffer_load_dwordx4 v2, s[12:15], s38 offen lds
    s_add_u32 m0, s34, 106496
    s_add_u32 s38, s36, 131072
    buffer_load_dwordx4 v2, s[12:15], s38 offen lds
    s_add_u32 m0, s34, 110592
    s_add_u32 s38, s36, 196608
    buffer_load_dwordx4 v2, s[12:15], s38 offen lds
    s_add_u32 m0, s34, 32768
    s_add_u32 s38, s37, 2048
    buffer_load_dwordx4 v3, s[16:19], s38 offen lds
    s_add_u32 m0, s34, 36864
    s_add_u32 s38, s37, 198656
    buffer_load_dwordx4 v3, s[16:19], s38 offen lds
    s_add_u32 m0, s34, 40960
    s_add_u32 s38, s37, 4096
    buffer_load_dwordx4 v3, s[16:19], s38 offen lds
    s_add_u32 m0, s34, 45056
    s_add_u32 s38, s37, 200704
    buffer_load_dwordx4 v3, s[16:19], s38 offen lds
    s_add_u32 s35, s59, 3
    s_and_b32 s35, s35, 15
    s_lshl_b32 s36, s35, 7
    s_mul_i32 s37, s35, 393216
    s_add_u32 m0, s34, 114688
    s_add_u32 s38, s36, 0
    buffer_load_dwordx4 v2, s[12:15], s38 offen lds
    s_add_u32 m0, s34, 118784
    s_add_u32 s38, s36, 65536
    buffer_load_dwordx4 v2, s[12:15], s38 offen lds
    ds_read_b128 v[64:67], v8 offset:0
    ds_read_b128 v[68:71], v8 offset:2048
    ds_read_b128 v[72:75], v9 offset:0
    ds_read_b128 v[76:79], v9 offset:2048
    s_waitcnt lgkmcnt(0)
    s_waitcnt vmcnt(10)
    s_barrier
    s_add_u32 m0, s34, 122880
    s_add_u32 s38, s36, 131072
    buffer_load_dwordx4 v2, s[12:15], s38 offen lds
    s_add_u32 m0, s34, 126976
    s_add_u32 s38, s36, 196608
    buffer_load_dwordx4 v2, s[12:15], s38 offen lds
    s_add_u32 m0, s34, 49152
    s_add_u32 s38, s37, 2048
    buffer_load_dwordx4 v3, s[16:19], s38 offen lds
    s_add_u32 m0, s34, 53248
    s_add_u32 s38, s37, 198656
    buffer_load_dwordx4 v3, s[16:19], s38 offen lds
    s_add_u32 m0, s34, 57344
    s_add_u32 s38, s37, 4096
    buffer_load_dwordx4 v3, s[16:19], s38 offen lds
    s_add_u32 m0, s34, 61440
    s_add_u32 s38, s37, 200704
    buffer_load_dwordx4 v3, s[16:19], s38 offen lds
    s_add_u32 s35, s59, 4
    s_and_b32 s35, s35, 15
    s_lshl_b32 s36, s35, 7
    s_mul_i32 s37, s35, 393216
    s_add_u32 m0, s34, 65536
    s_add_u32 s38, s36, 0
    buffer_load_dwordx4 v2, s[12:15], s38 offen lds
    s_add_u32 m0, s34, 69632
    s_add_u32 s38, s36, 65536
    buffer_load_dwordx4 v2, s[12:15], s38 offen lds
    s_add_u32 m0, s34, 73728
    s_add_u32 s38, s36, 131072
    buffer_load_dwordx4 v2, s[12:15], s38 offen lds
    s_add_u32 m0, s34, 77824
    s_add_u32 s38, s36, 196608
    buffer_load_dwordx4 v2, s[12:15], s38 offen lds
    ds_read_b128 v[80:83], v8 offset:16384
    ds_read_b128 v[84:87], v8 offset:18432
    ds_read_b128 v[88:91], v9 offset:16384
    ds_read_b128 v[92:95], v9 offset:18432
    s_waitcnt lgkmcnt(0)
    s_waitcnt vmcnt(12)
    s_barrier
    s_add_u32 m0, s34, 0
    s_add_u32 s38, s37, 2048
    buffer_load_dwordx4 v3, s[16:19], s38 offen lds
    s_add_u32 m0, s34, 4096
    s_add_u32 s38, s37, 198656
    buffer_load_dwordx4 v3, s[16:19], s38 offen lds
    s_add_u32 m0, s34, 8192
    s_add_u32 s38, s37, 4096
    buffer_load_dwordx4 v3, s[16:19], s38 offen lds
    s_add_u32 m0, s34, 12288
    s_add_u32 s38, s37, 200704
    buffer_load_dwordx4 v3, s[16:19], s38 offen lds
    s_add_u32 m0, s34, 131072
    s_nop 0
    buffer_load_dwordx4 v3, s[16:19], s37 offen lds
    s_add_u32 m0, s34, 135168
    s_add_u32 s38, s37, 196608
    buffer_load_dwordx4 v3, s[16:19], s38 offen lds
    s_add_u32 s35, s59, 5
    s_and_b32 s35, s35, 15
    s_lshl_b32 s36, s35, 7
    s_mul_i32 s37, s35, 393216
    s_add_u32 m0, s34, 81920
    s_add_u32 s38, s36, 0
    buffer_load_dwordx4 v2, s[12:15], s38 offen lds
    s_add_u32 m0, s34, 86016
    s_add_u32 s38, s36, 65536
    buffer_load_dwordx4 v2, s[12:15], s38 offen lds
    s_add_u32 m0, s34, 90112
    s_add_u32 s38, s36, 131072
    buffer_load_dwordx4 v2, s[12:15], s38 offen lds
    s_add_u32 m0, s34, 94208
    s_add_u32 s38, s36, 196608
    buffer_load_dwordx4 v2, s[12:15], s38 offen lds
    s_add_u32 m0, s34, 16384
    s_add_u32 s38, s37, 2048
    buffer_load_dwordx4 v3, s[16:19], s38 offen lds
    s_add_u32 m0, s34, 20480
    s_add_u32 s38, s37, 198656
    buffer_load_dwordx4 v3, s[16:19], s38 offen lds
    ds_read_b128 v[96:99], v8 offset:32768
    ds_read_b128 v[100:103], v8 offset:34816
    ds_read_b128 v[104:107], v9 offset:32768
    ds_read_b128 v[108:111], v9 offset:34816
    s_waitcnt lgkmcnt(0)
    s_waitcnt vmcnt(16)
    s_barrier
    s_add_u32 m0, s34, 24576
    s_add_u32 s38, s37, 4096
    buffer_load_dwordx4 v3, s[16:19], s38 offen lds
    s_add_u32 m0, s34, 28672
    s_add_u32 s38, s37, 200704
    buffer_load_dwordx4 v3, s[16:19], s38 offen lds
    s_add_u32 m0, s34, 139264
    s_nop 0
    buffer_load_dwordx4 v3, s[16:19], s37 offen lds
    s_add_u32 m0, s34, 143360
    s_add_u32 s38, s37, 196608
    buffer_load_dwordx4 v3, s[16:19], s38 offen lds
    s_add_u32 s35, s59, 6
    s_and_b32 s35, s35, 15
    s_lshl_b32 s36, s35, 7
    s_mul_i32 s37, s35, 393216
    s_add_u32 m0, s34, 98304
    s_add_u32 s38, s36, 0
    buffer_load_dwordx4 v2, s[12:15], s38 offen lds
    s_add_u32 m0, s34, 102400
    s_add_u32 s38, s36, 65536
    buffer_load_dwordx4 v2, s[12:15], s38 offen lds
    s_add_u32 m0, s34, 106496
    s_add_u32 s38, s36, 131072
    buffer_load_dwordx4 v2, s[12:15], s38 offen lds
    s_add_u32 m0, s34, 110592
    s_add_u32 s38, s36, 196608
    buffer_load_dwordx4 v2, s[12:15], s38 offen lds
    s_add_u32 m0, s34, 32768
    s_add_u32 s38, s37, 2048
    buffer_load_dwordx4 v3, s[16:19], s38 offen lds
    s_add_u32 m0, s34, 36864
    s_add_u32 s38, s37, 198656
    buffer_load_dwordx4 v3, s[16:19], s38 offen lds
    s_add_u32 m0, s34, 40960
    s_add_u32 s38, s37, 4096
    buffer_load_dwordx4 v3, s[16:19], s38 offen lds
    s_add_u32 m0, s34, 45056
    s_add_u32 s38, s37, 200704
    buffer_load_dwordx4 v3, s[16:19], s38 offen lds
    s_add_u32 m0, s34, 147456
    s_nop 0
    buffer_load_dwordx4 v3, s[16:19], s37 offen lds
    s_add_u32 m0, s34, 151552
    s_add_u32 s38, s37, 196608
    buffer_load_dwordx4 v3, s[16:19], s38 offen lds
    ds_read_b128 v[112:115], v8 offset:49152
    ds_read_b128 v[116:119], v8 offset:51200
    ds_read_b128 v[120:123], v9 offset:49152
    ds_read_b128 v[124:127], v9 offset:51200
    s_waitcnt lgkmcnt(0)
    s_waitcnt vmcnt(20)
    s_barrier
    s_add_u32 s35, s59, 7
    s_and_b32 s35, s35, 15
    s_lshl_b32 s36, s35, 7
    s_mul_i32 s37, s35, 393216
    s_add_u32 m0, s34, 114688
    s_add_u32 s38, s36, 0
    buffer_load_dwordx4 v2, s[12:15], s38 offen lds
    s_add_u32 m0, s34, 118784
    s_add_u32 s38, s36, 65536
    buffer_load_dwordx4 v2, s[12:15], s38 offen lds
    s_add_u32 m0, s34, 122880
    s_add_u32 s38, s36, 131072
    buffer_load_dwordx4 v2, s[12:15], s38 offen lds
    s_add_u32 m0, s34, 126976
    s_add_u32 s38, s36, 196608
    buffer_load_dwordx4 v2, s[12:15], s38 offen lds
    s_add_u32 m0, s34, 49152
    s_add_u32 s38, s37, 2048
    buffer_load_dwordx4 v3, s[16:19], s38 offen lds
    s_add_u32 m0, s34, 53248
    s_add_u32 s38, s37, 198656
    buffer_load_dwordx4 v3, s[16:19], s38 offen lds
    s_add_u32 m0, s34, 57344
    s_add_u32 s38, s37, 4096
    buffer_load_dwordx4 v3, s[16:19], s38 offen lds
    s_add_u32 m0, s34, 61440
    s_add_u32 s38, s37, 200704
    buffer_load_dwordx4 v3, s[16:19], s38 offen lds
    s_add_u32 m0, s34, 155648
    s_nop 0
    buffer_load_dwordx4 v3, s[16:19], s37 offen lds
    s_add_u32 m0, s34, 159744
    s_add_u32 s38, s37, 196608
    buffer_load_dwordx4 v3, s[16:19], s38 offen lds
    ds_read_b128 v[224:227], v8 offset:0
    ds_read_b128 v[228:231], v8 offset:2048
    ds_read_b64_tr_b16 v[32:33], v24 offset:0
    ds_read_b64_tr_b16 v[34:35], v24 offset:512
    ds_read_b64_tr_b16 v[36:37], v25 offset:0
    ds_read_b64_tr_b16 v[38:39], v25 offset:512
    ds_read_b64_tr_b16 v[40:41], v26 offset:0
    ds_read_b64_tr_b16 v[42:43], v26 offset:512
    ds_read_b64_tr_b16 v[44:45], v27 offset:0
    ds_read_b64_tr_b16 v[46:47], v27 offset:512
    s_waitcnt lgkmcnt(6)
    v_mfma_f32_16x16x32_bf16 v[192:195], v[32:35], v[224:227], v[192:195]
    ds_read_b128 v[232:235], v9 offset:0
    ds_read_b128 v[236:239], v9 offset:2048
    v_mfma_f32_16x16x32_bf16 v[208:211], v[32:35], v[228:231], v[208:211]
    ds_read_b64_tr_b16 v[48:49], v24 offset:4096
    ds_read_b64_tr_b16 v[50:51], v24 offset:4608
    s_waitcnt lgkmcnt(8)
    v_mfma_f32_16x16x32_bf16 v[196:199], v[36:39], v[224:227], v[196:199]
    ds_read_b64_tr_b16 v[52:53], v25 offset:4096
    ds_read_b64_tr_b16 v[54:55], v25 offset:4608
    v_mfma_f32_16x16x32_bf16 v[212:215], v[36:39], v[228:231], v[212:215]
    ds_read_b64_tr_b16 v[56:57], v26 offset:4096
    s_waitcnt lgkmcnt(9)
    v_mfma_f32_16x16x32_bf16 v[200:203], v[40:43], v[224:227], v[200:203]
    ds_read_b64_tr_b16 v[58:59], v26 offset:4608
    v_mfma_f32_16x16x32_bf16 v[216:219], v[40:43], v[228:231], v[216:219]
    ds_read_b64_tr_b16 v[60:61], v27 offset:4096
    s_waitcnt lgkmcnt(9)
    v_mfma_f32_16x16x32_bf16 v[204:207], v[44:47], v[224:227], v[204:207]
    ds_read_b64_tr_b16 v[62:63], v27 offset:4608
    v_mfma_f32_16x16x32_bf16 v[220:223], v[44:47], v[228:231], v[220:223]
    s_waitcnt lgkmcnt(6)
    v_mfma_f32_16x16x32_bf16 v[192:195], v[48:51], v[232:235], v[192:195]
    v_mfma_f32_16x16x32_bf16 v[208:211], v[48:51], v[236:239], v[208:211]
    s_waitcnt lgkmcnt(4)
    v_mfma_f32_16x16x32_bf16 v[196:199], v[52:55], v[232:235], v[196:199]
    v_mfma_f32_16x16x32_bf16 v[212:215], v[52:55], v[236:239], v[212:215]
    s_waitcnt lgkmcnt(2)
    v_mfma_f32_16x16x32_bf16 v[200:203], v[56:59], v[232:235], v[200:203]
    v_mfma_f32_16x16x32_bf16 v[216:219], v[56:59], v[236:239], v[216:219]
    s_waitcnt lgkmcnt(0)
    v_mfma_f32_16x16x32_bf16 v[204:207], v[60:63], v[232:235], v[204:207]
    v_mfma_f32_16x16x32_bf16 v[220:223], v[60:63], v[236:239], v[220:223]
    s_waitcnt lgkmcnt(0)
    s_waitcnt vmcnt(20)
    s_barrier
    s_add_u32 s35, s59, 8
    s_and_b32 s35, s35, 15
    s_lshl_b32 s36, s35, 7
    s_mul_i32 s37, s35, 393216
    s_add_u32 m0, s34, 65536
    s_add_u32 s38, s36, 0
    buffer_load_dwordx4 v2, s[12:15], s38 offen lds
    s_add_u32 m0, s34, 69632
    s_add_u32 s38, s36, 65536
    buffer_load_dwordx4 v2, s[12:15], s38 offen lds
    s_add_u32 m0, s34, 73728
    s_add_u32 s38, s36, 131072
    buffer_load_dwordx4 v2, s[12:15], s38 offen lds
    s_add_u32 m0, s34, 77824
    s_add_u32 s38, s36, 196608
    buffer_load_dwordx4 v2, s[12:15], s38 offen lds
    s_add_u32 m0, s34, 0
    s_add_u32 s38, s37, 2048
    buffer_load_dwordx4 v3, s[16:19], s38 offen lds
    s_add_u32 m0, s34, 4096
    s_add_u32 s38, s37, 198656
    buffer_load_dwordx4 v3, s[16:19], s38 offen lds
    s_add_u32 m0, s34, 8192
    s_add_u32 s38, s37, 4096
    buffer_load_dwordx4 v3, s[16:19], s38 offen lds
    s_add_u32 m0, s34, 12288
    s_add_u32 s38, s37, 200704
    buffer_load_dwordx4 v3, s[16:19], s38 offen lds
    ds_read_b128 v[224:227], v8 offset:16384
    ds_read_b128 v[228:231], v8 offset:18432
    ds_read_b64_tr_b16 v[32:33], v24 offset:8192
    ds_read_b64_tr_b16 v[34:35], v24 offset:8704
    ds_read_b64_tr_b16 v[36:37], v25 offset:8192
    ds_read_b64_tr_b16 v[38:39], v25 offset:8704
    ds_read_b64_tr_b16 v[40:41], v26 offset:8192
    ds_read_b64_tr_b16 v[42:43], v26 offset:8704
    ds_read_b64_tr_b16 v[44:45], v27 offset:8192
    ds_read_b64_tr_b16 v[46:47], v27 offset:8704
    s_waitcnt lgkmcnt(6)
    v_mfma_f32_16x16x32_bf16 v[192:195], v[32:35], v[224:227], v[192:195]
    ds_read_b128 v[232:235], v9 offset:16384
    ds_read_b128 v[236:239], v9 offset:18432
    v_mfma_f32_16x16x32_bf16 v[208:211], v[32:35], v[228:231], v[208:211]
    ds_read_b64_tr_b16 v[48:49], v24 offset:12288
    ds_read_b64_tr_b16 v[50:51], v24 offset:12800
    s_waitcnt lgkmcnt(8)
    v_mfma_f32_16x16x32_bf16 v[196:199], v[36:39], v[224:227], v[196:199]
    ds_read_b64_tr_b16 v[52:53], v25 offset:12288
    ds_read_b64_tr_b16 v[54:55], v25 offset:12800
    v_mfma_f32_16x16x32_bf16 v[212:215], v[36:39], v[228:231], v[212:215]
    ds_read_b64_tr_b16 v[56:57], v26 offset:12288
    s_waitcnt lgkmcnt(9)
    v_mfma_f32_16x16x32_bf16 v[200:203], v[40:43], v[224:227], v[200:203]
    ds_read_b64_tr_b16 v[58:59], v26 offset:12800
    v_mfma_f32_16x16x32_bf16 v[216:219], v[40:43], v[228:231], v[216:219]
    ds_read_b64_tr_b16 v[60:61], v27 offset:12288
    s_waitcnt lgkmcnt(9)
    v_mfma_f32_16x16x32_bf16 v[204:207], v[44:47], v[224:227], v[204:207]
    ds_read_b64_tr_b16 v[62:63], v27 offset:12800
    v_mfma_f32_16x16x32_bf16 v[220:223], v[44:47], v[228:231], v[220:223]
    s_waitcnt lgkmcnt(6)
    v_mfma_f32_16x16x32_bf16 v[192:195], v[48:51], v[232:235], v[192:195]
    v_mfma_f32_16x16x32_bf16 v[208:211], v[48:51], v[236:239], v[208:211]
    s_waitcnt lgkmcnt(4)
    v_mfma_f32_16x16x32_bf16 v[196:199], v[52:55], v[232:235], v[196:199]
    v_mfma_f32_16x16x32_bf16 v[212:215], v[52:55], v[236:239], v[212:215]
    s_waitcnt lgkmcnt(2)
    v_mfma_f32_16x16x32_bf16 v[200:203], v[56:59], v[232:235], v[200:203]
    v_mfma_f32_16x16x32_bf16 v[216:219], v[56:59], v[236:239], v[216:219]
    s_waitcnt lgkmcnt(0)
    v_mfma_f32_16x16x32_bf16 v[204:207], v[60:63], v[232:235], v[204:207]
    v_mfma_f32_16x16x32_bf16 v[220:223], v[60:63], v[236:239], v[220:223]
    s_waitcnt lgkmcnt(0)
    s_waitcnt vmcnt(18)
    s_barrier
    s_add_u32 s35, s59, 9
    s_and_b32 s35, s35, 15
    s_lshl_b32 s36, s35, 7
    s_mul_i32 s37, s35, 393216
    s_add_u32 m0, s34, 81920
    s_add_u32 s38, s36, 0
    buffer_load_dwordx4 v2, s[12:15], s38 offen lds
    s_add_u32 m0, s34, 86016
    s_add_u32 s38, s36, 65536
    buffer_load_dwordx4 v2, s[12:15], s38 offen lds
    s_add_u32 m0, s34, 90112
    s_add_u32 s38, s36, 131072
    buffer_load_dwordx4 v2, s[12:15], s38 offen lds
    s_add_u32 m0, s34, 94208
    s_add_u32 s38, s36, 196608
    buffer_load_dwordx4 v2, s[12:15], s38 offen lds
    s_add_u32 m0, s34, 16384
    s_add_u32 s38, s37, 2048
    buffer_load_dwordx4 v3, s[16:19], s38 offen lds
    s_add_u32 m0, s34, 20480
    s_add_u32 s38, s37, 198656
    buffer_load_dwordx4 v3, s[16:19], s38 offen lds
    s_add_u32 m0, s34, 24576
    s_add_u32 s38, s37, 4096
    buffer_load_dwordx4 v3, s[16:19], s38 offen lds
    s_add_u32 m0, s34, 28672
    s_add_u32 s38, s37, 200704
    buffer_load_dwordx4 v3, s[16:19], s38 offen lds
    ds_read_b128 v[224:227], v8 offset:32768
    ds_read_b128 v[228:231], v8 offset:34816
    ds_read_b64_tr_b16 v[32:33], v24 offset:16384
    ds_read_b64_tr_b16 v[34:35], v24 offset:16896
    ds_read_b64_tr_b16 v[36:37], v25 offset:16384
    ds_read_b64_tr_b16 v[38:39], v25 offset:16896
    ds_read_b64_tr_b16 v[40:41], v26 offset:16384
    ds_read_b64_tr_b16 v[42:43], v26 offset:16896
    ds_read_b64_tr_b16 v[44:45], v27 offset:16384
    ds_read_b64_tr_b16 v[46:47], v27 offset:16896
    s_waitcnt lgkmcnt(6)
    v_mfma_f32_16x16x32_bf16 v[192:195], v[32:35], v[224:227], v[192:195]
    ds_read_b128 v[232:235], v9 offset:32768
    ds_read_b128 v[236:239], v9 offset:34816
    v_mfma_f32_16x16x32_bf16 v[208:211], v[32:35], v[228:231], v[208:211]
    ds_read_b64_tr_b16 v[48:49], v24 offset:20480
    ds_read_b64_tr_b16 v[50:51], v24 offset:20992
    s_waitcnt lgkmcnt(8)
    v_mfma_f32_16x16x32_bf16 v[196:199], v[36:39], v[224:227], v[196:199]
    ds_read_b64_tr_b16 v[52:53], v25 offset:20480
    ds_read_b64_tr_b16 v[54:55], v25 offset:20992
    v_mfma_f32_16x16x32_bf16 v[212:215], v[36:39], v[228:231], v[212:215]
    ds_read_b64_tr_b16 v[56:57], v26 offset:20480
    s_waitcnt lgkmcnt(9)
    v_mfma_f32_16x16x32_bf16 v[200:203], v[40:43], v[224:227], v[200:203]
    ds_read_b64_tr_b16 v[58:59], v26 offset:20992
    v_mfma_f32_16x16x32_bf16 v[216:219], v[40:43], v[228:231], v[216:219]
    ds_read_b64_tr_b16 v[60:61], v27 offset:20480
    s_waitcnt lgkmcnt(9)
    v_mfma_f32_16x16x32_bf16 v[204:207], v[44:47], v[224:227], v[204:207]
    ds_read_b64_tr_b16 v[62:63], v27 offset:20992
    v_mfma_f32_16x16x32_bf16 v[220:223], v[44:47], v[228:231], v[220:223]
    s_waitcnt lgkmcnt(6)
    v_mfma_f32_16x16x32_bf16 v[192:195], v[48:51], v[232:235], v[192:195]
    v_mfma_f32_16x16x32_bf16 v[208:211], v[48:51], v[236:239], v[208:211]
    s_waitcnt lgkmcnt(4)
    v_mfma_f32_16x16x32_bf16 v[196:199], v[52:55], v[232:235], v[196:199]
    v_mfma_f32_16x16x32_bf16 v[212:215], v[52:55], v[236:239], v[212:215]
    s_waitcnt lgkmcnt(2)
    v_mfma_f32_16x16x32_bf16 v[200:203], v[56:59], v[232:235], v[200:203]
    v_mfma_f32_16x16x32_bf16 v[216:219], v[56:59], v[236:239], v[216:219]
    s_waitcnt lgkmcnt(0)
    v_mfma_f32_16x16x32_bf16 v[204:207], v[60:63], v[232:235], v[204:207]
    v_mfma_f32_16x16x32_bf16 v[220:223], v[60:63], v[236:239], v[220:223]
    s_waitcnt lgkmcnt(0)
    s_waitcnt vmcnt(16)
    s_barrier
    s_add_u32 s35, s59, 10
    s_and_b32 s35, s35, 15
    s_lshl_b32 s36, s35, 7
    s_mul_i32 s37, s35, 393216
    s_add_u32 m0, s34, 98304
    s_add_u32 s38, s36, 0
    buffer_load_dwordx4 v2, s[12:15], s38 offen lds
    s_add_u32 m0, s34, 102400
    s_add_u32 s38, s36, 65536
    buffer_load_dwordx4 v2, s[12:15], s38 offen lds
    s_add_u32 m0, s34, 106496
    s_add_u32 s38, s36, 131072
    buffer_load_dwordx4 v2, s[12:15], s38 offen lds
    s_add_u32 m0, s34, 110592
    s_add_u32 s38, s36, 196608
    buffer_load_dwordx4 v2, s[12:15], s38 offen lds
    s_add_u32 m0, s34, 32768
    s_add_u32 s38, s37, 2048
    buffer_load_dwordx4 v3, s[16:19], s38 offen lds
    s_add_u32 m0, s34, 36864
    s_add_u32 s38, s37, 198656
    buffer_load_dwordx4 v3, s[16:19], s38 offen lds
    s_add_u32 m0, s34, 40960
    s_add_u32 s38, s37, 4096
    buffer_load_dwordx4 v3, s[16:19], s38 offen lds
    s_add_u32 m0, s34, 45056
    s_add_u32 s38, s37, 200704
    buffer_load_dwordx4 v3, s[16:19], s38 offen lds
    ds_read_b128 v[224:227], v8 offset:49152
    ds_read_b128 v[228:231], v8 offset:51200
    ds_read_b64_tr_b16 v[32:33], v24 offset:24576
    ds_read_b64_tr_b16 v[34:35], v24 offset:25088
    ds_read_b64_tr_b16 v[36:37], v25 offset:24576
    ds_read_b64_tr_b16 v[38:39], v25 offset:25088
    ds_read_b64_tr_b16 v[40:41], v26 offset:24576
    ds_read_b64_tr_b16 v[42:43], v26 offset:25088
    ds_read_b64_tr_b16 v[44:45], v27 offset:24576
    ds_read_b64_tr_b16 v[46:47], v27 offset:25088
    s_waitcnt lgkmcnt(6)
    v_mfma_f32_16x16x32_bf16 v[192:195], v[32:35], v[224:227], v[192:195]
    ds_read_b128 v[232:235], v9 offset:49152
    ds_read_b128 v[236:239], v9 offset:51200
    v_mfma_f32_16x16x32_bf16 v[208:211], v[32:35], v[228:231], v[208:211]
    ds_read_b64_tr_b16 v[48:49], v24 offset:28672
    ds_read_b64_tr_b16 v[50:51], v24 offset:29184
    s_waitcnt lgkmcnt(8)
    v_mfma_f32_16x16x32_bf16 v[196:199], v[36:39], v[224:227], v[196:199]
    ds_read_b64_tr_b16 v[52:53], v25 offset:28672
    ds_read_b64_tr_b16 v[54:55], v25 offset:29184
    v_mfma_f32_16x16x32_bf16 v[212:215], v[36:39], v[228:231], v[212:215]
    ds_read_b64_tr_b16 v[56:57], v26 offset:28672
    s_waitcnt lgkmcnt(9)
    v_mfma_f32_16x16x32_bf16 v[200:203], v[40:43], v[224:227], v[200:203]
    ds_read_b64_tr_b16 v[58:59], v26 offset:29184
    v_mfma_f32_16x16x32_bf16 v[216:219], v[40:43], v[228:231], v[216:219]
    ds_read_b64_tr_b16 v[60:61], v27 offset:28672
    s_waitcnt lgkmcnt(9)
    v_mfma_f32_16x16x32_bf16 v[204:207], v[44:47], v[224:227], v[204:207]
    ds_read_b64_tr_b16 v[62:63], v27 offset:29184
    v_mfma_f32_16x16x32_bf16 v[220:223], v[44:47], v[228:231], v[220:223]
    s_waitcnt lgkmcnt(6)
    v_mfma_f32_16x16x32_bf16 v[192:195], v[48:51], v[232:235], v[192:195]
    v_mfma_f32_16x16x32_bf16 v[208:211], v[48:51], v[236:239], v[208:211]
    s_waitcnt lgkmcnt(4)
    v_mfma_f32_16x16x32_bf16 v[196:199], v[52:55], v[232:235], v[196:199]
    v_mfma_f32_16x16x32_bf16 v[212:215], v[52:55], v[236:239], v[212:215]
    s_waitcnt lgkmcnt(2)
    v_mfma_f32_16x16x32_bf16 v[200:203], v[56:59], v[232:235], v[200:203]
    v_mfma_f32_16x16x32_bf16 v[216:219], v[56:59], v[236:239], v[216:219]
    s_waitcnt lgkmcnt(0)
    v_mfma_f32_16x16x32_bf16 v[204:207], v[60:63], v[232:235], v[204:207]
    v_mfma_f32_16x16x32_bf16 v[220:223], v[60:63], v[236:239], v[220:223]
    s_waitcnt lgkmcnt(0)
    s_waitcnt vmcnt(16)
    s_barrier
    s_add_u32 s35, s59, 11
    s_and_b32 s35, s35, 15
    s_lshl_b32 s36, s35, 7
    s_mul_i32 s37, s35, 393216
    s_add_u32 m0, s34, 114688
    s_add_u32 s38, s36, 0
    buffer_load_dwordx4 v2, s[12:15], s38 offen lds
    s_add_u32 m0, s34, 118784
    s_add_u32 s38, s36, 65536
    buffer_load_dwordx4 v2, s[12:15], s38 offen lds
    s_add_u32 m0, s34, 122880
    s_add_u32 s38, s36, 131072
    buffer_load_dwordx4 v2, s[12:15], s38 offen lds
    s_add_u32 m0, s34, 126976
    s_add_u32 s38, s36, 196608
    buffer_load_dwordx4 v2, s[12:15], s38 offen lds
    s_add_u32 m0, s34, 49152
    s_add_u32 s38, s37, 2048
    buffer_load_dwordx4 v3, s[16:19], s38 offen lds
    s_add_u32 m0, s34, 53248
    s_add_u32 s38, s37, 198656
    buffer_load_dwordx4 v3, s[16:19], s38 offen lds
    s_add_u32 m0, s34, 57344
    s_add_u32 s38, s37, 4096
    buffer_load_dwordx4 v3, s[16:19], s38 offen lds
    s_add_u32 m0, s34, 61440
    s_add_u32 s38, s37, 200704
    buffer_load_dwordx4 v3, s[16:19], s38 offen lds
    s_add_u32 s35, s59, 12
    s_and_b32 s35, s35, 15
    s_lshl_b32 s36, s35, 7
    s_mul_i32 s37, s35, 393216
    s_add_u32 m0, s34, 131072
    s_nop 0
    buffer_load_dwordx4 v3, s[16:19], s37 offen lds
    s_add_u32 m0, s34, 135168
    s_add_u32 s38, s37, 196608
    buffer_load_dwordx4 v3, s[16:19], s38 offen lds
    ds_read_b128 v[128:131], v8 offset:0
    ds_read_b128 v[132:135], v8 offset:2048
    ds_read_b128 v[136:139], v9 offset:0
    ds_read_b128 v[140:143], v9 offset:2048
    s_waitcnt lgkmcnt(0)
    s_waitcnt vmcnt(18)
    s_barrier
    s_add_u32 m0, s34, 65536
    s_add_u32 s38, s36, 0
    buffer_load_dwordx4 v2, s[12:15], s38 offen lds
    s_add_u32 m0, s34, 69632
    s_add_u32 s38, s36, 65536
    buffer_load_dwordx4 v2, s[12:15], s38 offen lds
    s_add_u32 m0, s34, 73728
    s_add_u32 s38, s36, 131072
    buffer_load_dwordx4 v2, s[12:15], s38 offen lds
    s_add_u32 m0, s34, 77824
    s_add_u32 s38, s36, 196608
    buffer_load_dwordx4 v2, s[12:15], s38 offen lds
    s_add_u32 m0, s34, 0
    s_add_u32 s38, s37, 2048
    buffer_load_dwordx4 v3, s[16:19], s38 offen lds
    s_add_u32 m0, s34, 4096
    s_add_u32 s38, s37, 198656
    buffer_load_dwordx4 v3, s[16:19], s38 offen lds
    s_add_u32 m0, s34, 8192
    s_add_u32 s38, s37, 4096
    buffer_load_dwordx4 v3, s[16:19], s38 offen lds
    s_add_u32 m0, s34, 12288
    s_add_u32 s38, s37, 200704
    buffer_load_dwordx4 v3, s[16:19], s38 offen lds
    s_add_u32 s35, s59, 13
    s_and_b32 s35, s35, 15
    s_lshl_b32 s36, s35, 7
    s_mul_i32 s37, s35, 393216
    s_add_u32 m0, s34, 139264
    s_nop 0
    buffer_load_dwordx4 v3, s[16:19], s37 offen lds
    s_add_u32 m0, s34, 143360
    s_add_u32 s38, s37, 196608
    buffer_load_dwordx4 v3, s[16:19], s38 offen lds
    ds_read_b128 v[144:147], v8 offset:16384
    ds_read_b128 v[148:151], v8 offset:18432
    ds_read_b128 v[152:155], v9 offset:16384
    ds_read_b128 v[156:159], v9 offset:18432
    s_waitcnt lgkmcnt(0)
    s_waitcnt vmcnt(20)
    s_barrier
    s_add_u32 m0, s34, 81920
    s_add_u32 s38, s36, 0
    buffer_load_dwordx4 v2, s[12:15], s38 offen lds
    s_add_u32 m0, s34, 86016
    s_add_u32 s38, s36, 65536
    buffer_load_dwordx4 v2, s[12:15], s38 offen lds
    s_add_u32 m0, s34, 90112
    s_add_u32 s38, s36, 131072
    buffer_load_dwordx4 v2, s[12:15], s38 offen lds
    s_add_u32 m0, s34, 94208
    s_add_u32 s38, s36, 196608
    buffer_load_dwordx4 v2, s[12:15], s38 offen lds
    s_add_u32 m0, s34, 16384
    s_add_u32 s38, s37, 2048
    buffer_load_dwordx4 v3, s[16:19], s38 offen lds
    s_add_u32 m0, s34, 20480
    s_add_u32 s38, s37, 198656
    buffer_load_dwordx4 v3, s[16:19], s38 offen lds
    s_add_u32 m0, s34, 24576
    s_add_u32 s38, s37, 4096
    buffer_load_dwordx4 v3, s[16:19], s38 offen lds
    s_add_u32 m0, s34, 28672
    s_add_u32 s38, s37, 200704
    buffer_load_dwordx4 v3, s[16:19], s38 offen lds
    s_add_u32 s35, s59, 14
    s_and_b32 s35, s35, 15
    s_lshl_b32 s36, s35, 7
    s_mul_i32 s37, s35, 393216
    s_add_u32 m0, s34, 147456
    s_nop 0
    buffer_load_dwordx4 v3, s[16:19], s37 offen lds
    s_add_u32 m0, s34, 151552
    s_add_u32 s38, s37, 196608
    buffer_load_dwordx4 v3, s[16:19], s38 offen lds
    ds_read_b128 v[160:163], v8 offset:32768
    ds_read_b128 v[164:167], v8 offset:34816
    ds_read_b128 v[168:171], v9 offset:32768
    ds_read_b128 v[172:175], v9 offset:34816
    s_waitcnt lgkmcnt(0)
    s_waitcnt vmcnt(22)
    s_barrier
    s_add_u32 m0, s34, 98304
    s_add_u32 s38, s36, 0
    buffer_load_dwordx4 v2, s[12:15], s38 offen lds
    s_add_u32 m0, s34, 102400
    s_add_u32 s38, s36, 65536
    buffer_load_dwordx4 v2, s[12:15], s38 offen lds
    s_add_u32 m0, s34, 106496
    s_add_u32 s38, s36, 131072
    buffer_load_dwordx4 v2, s[12:15], s38 offen lds
    s_add_u32 m0, s34, 110592
    s_add_u32 s38, s36, 196608
    buffer_load_dwordx4 v2, s[12:15], s38 offen lds
    s_add_u32 m0, s34, 32768
    s_add_u32 s38, s37, 2048
    buffer_load_dwordx4 v3, s[16:19], s38 offen lds
    s_add_u32 m0, s34, 36864
    s_add_u32 s38, s37, 198656
    buffer_load_dwordx4 v3, s[16:19], s38 offen lds
    s_add_u32 m0, s34, 40960
    s_add_u32 s38, s37, 4096
    buffer_load_dwordx4 v3, s[16:19], s38 offen lds
    s_add_u32 m0, s34, 45056
    s_add_u32 s38, s37, 200704
    buffer_load_dwordx4 v3, s[16:19], s38 offen lds
    s_add_u32 s35, s59, 15
    s_and_b32 s35, s35, 15
    s_lshl_b32 s36, s35, 7
    s_mul_i32 s37, s35, 393216
    s_add_u32 m0, s34, 155648
    s_nop 0
    buffer_load_dwordx4 v3, s[16:19], s37 offen lds
    s_add_u32 m0, s34, 159744
    s_add_u32 s38, s37, 196608
    buffer_load_dwordx4 v3, s[16:19], s38 offen lds
    ds_read_b128 v[176:179], v8 offset:49152
    ds_read_b128 v[180:183], v8 offset:51200
    ds_read_b128 v[184:187], v9 offset:49152
    ds_read_b128 v[188:191], v9 offset:51200
    s_waitcnt lgkmcnt(0)
    s_waitcnt vmcnt(22)
    s_barrier
    s_add_u32 m0, s34, 114688
    s_add_u32 s38, s36, 0
    buffer_load_dwordx4 v2, s[12:15], s38 offen lds
    s_add_u32 m0, s34, 118784
    s_add_u32 s38, s36, 65536
    buffer_load_dwordx4 v2, s[12:15], s38 offen lds
    s_add_u32 m0, s34, 122880
    s_add_u32 s38, s36, 131072
    buffer_load_dwordx4 v2, s[12:15], s38 offen lds
    s_add_u32 m0, s34, 126976
    s_add_u32 s38, s36, 196608
    buffer_load_dwordx4 v2, s[12:15], s38 offen lds
    s_add_u32 m0, s34, 49152
    s_add_u32 s38, s37, 2048
    buffer_load_dwordx4 v3, s[16:19], s38 offen lds
    s_add_u32 m0, s34, 53248
    s_add_u32 s38, s37, 198656
    buffer_load_dwordx4 v3, s[16:19], s38 offen lds
    s_add_u32 m0, s34, 57344
    s_add_u32 s38, s37, 4096
    buffer_load_dwordx4 v3, s[16:19], s38 offen lds
    s_add_u32 m0, s34, 61440
    s_add_u32 s38, s37, 200704
    buffer_load_dwordx4 v3, s[16:19], s38 offen lds
    s_load_dwordx4 s[4:7], s[40:41], 0
    s_waitcnt vmcnt(20)
    s_barrier
    s_add_u32 s35, s59, 0
    s_and_b32 s35, s35, 15
    s_lshl_b32 s36, s35, 7
    s_mul_i32 s37, s35, 393216
    s_add_u32 m0, s34, 0
    s_nop 0
    buffer_load_dwordx4 v3, s[16:19], s37 offen lds
    s_add_u32 m0, s34, 4096
    s_add_u32 s38, s37, 196608
    buffer_load_dwordx4 v3, s[16:19], s38 offen lds
    s_waitcnt vmcnt(12)
    s_barrier
    s_add_u32 s35, s59, 1
    s_and_b32 s35, s35, 15
    s_lshl_b32 s36, s35, 7
    s_mul_i32 s37, s35, 393216
    s_add_u32 m0, s34, 16384
    s_nop 0
    buffer_load_dwordx4 v3, s[16:19], s37 offen lds
    s_add_u32 m0, s34, 20480
    s_add_u32 s38, s37, 196608
    buffer_load_dwordx4 v3, s[16:19], s38 offen lds
    s_waitcnt vmcnt(4)
    s_barrier
    s_add_u32 s35, s59, 2
    s_and_b32 s35, s35, 15
    s_lshl_b32 s36, s35, 7
    s_mul_i32 s37, s35, 393216
    s_add_u32 m0, s34, 32768
    s_nop 0
    buffer_load_dwordx4 v3, s[16:19], s37 offen lds
    s_add_u32 m0, s34, 36864
    s_add_u32 s38, s37, 196608
    buffer_load_dwordx4 v3, s[16:19], s38 offen lds
    s_waitcnt lgkmcnt(0)
    s_and_b64 s[4:5], s[4:5], s[6:7]
    s_and_b32 s4, s4, s5
    s_cmp_eq_u32 s4, 0x01010101
    s_cbranch_scc1 L_INITOK
    v_and_b32 v28, 3, v0
    v_lshlrev_b32 v28, 2, v28
    s_mov_b32 s35, 200000
    s_mov_b32 s29, 0x01010101
L_INITCHK:
    buffer_load_dword v29, v28, s[52:55], 0 offen sc1
    s_waitcnt vmcnt(0)
    v_cmp_ne_u32 vcc, s29, v29
    s_cmp_eq_u64 vcc, 0
    s_cbranch_scc1 L_INITOK
    s_sub_u32 s35, s35, 1
    s_cmp_lg_u32 s35, 0
    s_cbranch_scc1 L_INITCHK
L_INITOK:
    s_barrier
    s_add_u32 s35, s59, 3
    s_and_b32 s35, s35, 15
    s_lshl_b32 s36, s35, 7
    s_mul_i32 s37, s35, 393216
    s_add_u32 m0, s34, 49152
    s_nop 0
    buffer_load_dwordx4 v3, s[16:19], s37 offen lds
    s_add_u32 m0, s34, 53248
    s_add_u32 s38, s37, 196608
    buffer_load_dwordx4 v3, s[16:19], s38 offen lds
    s_waitcnt vmcnt(0)
    s_barrier
    s_add_u32 s35, s59, 8
    s_and_b32 s35, s35, 15
    s_lshl_b32 s36, s35, 7
    s_mul_i32 s37, s35, 393216
    s_add_u32 m0, s34, 8192
    s_nop 0
    buffer_load_dwordx4 v3, s[16:19], s37 offen lds
    s_add_u32 m0, s34, 12288
    s_add_u32 s38, s37, 196608
    buffer_load_dwordx4 v3, s[16:19], s38 offen lds
    s_add_u32 s35, s59, 9
    s_and_b32 s35, s35, 15
    s_lshl_b32 s36, s35, 7
    s_mul_i32 s37, s35, 393216
    s_add_u32 m0, s34, 24576
    s_nop 0
    buffer_load_dwordx4 v3, s[16:19], s37 offen lds
    s_add_u32 m0, s34, 28672
    s_add_u32 s38, s37, 196608
    buffer_load_dwordx4 v3, s[16:19], s38 offen lds
    s_add_u32 s35, s59, 10
    s_and_b32 s35, s35, 15
    s_lshl_b32 s36, s35, 7
    s_mul_i32 s37, s35, 393216
    s_add_u32 m0, s34, 40960
    s_nop 0
    buffer_load_dwordx4 v3, s[16:19], s37 offen lds
    s_add_u32 m0, s34, 45056
    s_add_u32 s38, s37, 196608
    buffer_load_dwordx4 v3, s[16:19], s38 offen lds
    s_add_u32 s35, s59, 11
    s_and_b32 s35, s35, 15
    s_lshl_b32 s36, s35, 7
    s_mul_i32 s37, s35, 393216
    s_add_u32 m0, s34, 57344
    s_nop 0
    buffer_load_dwordx4 v3, s[16:19], s37 offen lds
    s_add_u32 m0, s34, 61440
    s_add_u32 s38, s37, 196608
    buffer_load_dwordx4 v3, s[16:19], s38 offen lds
    ds_read_b128 v[224:227], v8 offset:0
    ds_read_b128 v[228:231], v8 offset:2048
    ds_read_b64_tr_b16 v[32:33], v24 offset:0
    ds_read_b64_tr_b16 v[34:35], v24 offset:512
    ds_read_b64_tr_b16 v[36:37], v25 offset:0
    ds_read_b64_tr_b16 v[38:39], v25 offset:512
    ds_read_b64_tr_b16 v[40:41], v26 offset:0
    ds_read_b64_tr_b16 v[42:43], v26 offset:512
    ds_read_b64_tr_b16 v[44:45], v27 offset:0
    ds_read_b64_tr_b16 v[46:47], v27 offset:512
    s_waitcnt lgkmcnt(6)
    v_mfma_f32_16x16x32_bf16 v[192:195], v[32:35], v[224:227], v[192:195]
    ds_read_b128 v[232:235], v9 offset:0
    ds_read_b128 v[236:239], v9 offset:2048
    v_mfma_f32_16x16x32_bf16 v[208:211], v[32:35], v[228:231], v[208:211]
    ds_read_b64_tr_b16 v[48:49], v24 offset:4096
    ds_read_b64_tr_b16 v[50:51], v24 offset:4608
    s_waitcnt lgkmcnt(8)
    v_mfma_f32_16x16x32_bf16 v[196:199], v[36:39], v[224:227], v[196:199]
    ds_read_b64_tr_b16 v[52:53], v25 offset:4096
    ds_read_b64_tr_b16 v[54:55], v25 offset:4608
    v_mfma_f32_16x16x32_bf16 v[212:215], v[36:39], v[228:231], v[212:215]
    ds_read_b64_tr_b16 v[56:57], v26 offset:4096
    s_waitcnt lgkmcnt(9)
    v_mfma_f32_16x16x32_bf16 v[200:203], v[40:43], v[224:227], v[200:203]
    ds_read_b64_tr_b16 v[58:59], v26 offset:4608
    v_mfma_f32_16x16x32_bf16 v[216:219], v[40:43], v[228:231], v[216:219]
    ds_read_b64_tr_b16 v[60:61], v27 offset:4096
    s_waitcnt lgkmcnt(9)
    v_mfma_f32_16x16x32_bf16 v[204:207], v[44:47], v[224:227], v[204:207]
    ds_read_b64_tr_b16 v[62:63], v27 offset:4608
    v_mfma_f32_16x16x32_bf16 v[220:223], v[44:47], v[228:231], v[220:223]
    s_waitcnt lgkmcnt(6)
    v_mfma_f32_16x16x32_bf16 v[192:195], v[48:51], v[232:235], v[192:195]
    ds_read_b128 v[224:227], v8 offset:16384
    ds_read_b128 v[228:231], v8 offset:18432
    v_mfma_f32_16x16x32_bf16 v[208:211], v[48:51], v[236:239], v[208:211]
    ds_read_b64_tr_b16 v[32:33], v24 offset:8192
    ds_read_b64_tr_b16 v[34:35], v24 offset:8704
    s_waitcnt lgkmcnt(8)
    v_mfma_f32_16x16x32_bf16 v[196:199], v[52:55], v[232:235], v[196:199]
    ds_read_b64_tr_b16 v[36:37], v25 offset:8192
    ds_read_b64_tr_b16 v[38:39], v25 offset:8704
    v_mfma_f32_16x16x32_bf16 v[212:215], v[52:55], v[236:239], v[212:215]
    ds_read_b64_tr_b16 v[40:41], v26 offset:8192
    s_waitcnt lgkmcnt(9)
    v_mfma_f32_16x16x32_bf16 v[200:203], v[56:59], v[232:235], v[200:203]
    ds_read_b64_tr_b16 v[42:43], v26 offset:8704
    v_mfma_f32_16x16x32_bf16 v[216:219], v[56:59], v[236:239], v[216:219]
    ds_read_b64_tr_b16 v[44:45], v27 offset:8192
    s_waitcnt lgkmcnt(9)
    v_mfma_f32_16x16x32_bf16 v[204:207], v[60:63], v[232:235], v[204:207]
    ds_read_b64_tr_b16 v[46:47], v27 offset:8704
    v_mfma_f32_16x16x32_bf16 v[220:223], v[60:63], v[236:239], v[220:223]
    s_waitcnt lgkmcnt(6)
    v_mfma_f32_16x16x32_bf16 v[192:195], v[32:35], v[224:227], v[192:195]
    ds_read_b128 v[232:235], v9 offset:16384
    ds_read_b128 v[236:239], v9 offset:18432
    v_mfma_f32_16x16x32_bf16 v[208:211], v[32:35], v[228:231], v[208:211]
    ds_read_b64_tr_b16 v[48:49], v24 offset:12288
    ds_read_b64_tr_b16 v[50:51], v24 offset:12800
    s_waitcnt lgkmcnt(8)
    v_mfma_f32_16x16x32_bf16 v[196:199], v[36:39], v[224:227], v[196:199]
    ds_read_b64_tr_b16 v[52:53], v25 offset:12288
    ds_read_b64_tr_b16 v[54:55], v25 offset:12800
    v_mfma_f32_16x16x32_bf16 v[212:215], v[36:39], v[228:231], v[212:215]
    ds_read_b64_tr_b16 v[56:57], v26 offset:12288
    s_waitcnt lgkmcnt(9)
    v_mfma_f32_16x16x32_bf16 v[200:203], v[40:43], v[224:227], v[200:203]
    ds_read_b64_tr_b16 v[58:59], v26 offset:12800
    v_mfma_f32_16x16x32_bf16 v[216:219], v[40:43], v[228:231], v[216:219]
    ds_read_b64_tr_b16 v[60:61], v27 offset:12288
    s_waitcnt lgkmcnt(9)
    v_mfma_f32_16x16x32_bf16 v[204:207], v[44:47], v[224:227], v[204:207]
    ds_read_b64_tr_b16 v[62:63], v27 offset:12800
    v_mfma_f32_16x16x32_bf16 v[220:223], v[44:47], v[228:231], v[220:223]
    s_waitcnt lgkmcnt(6)
    v_mfma_f32_16x16x32_bf16 v[192:195], v[48:51], v[232:235], v[192:195]
    ds_read_b128 v[224:227], v8 offset:32768
    ds_read_b128 v[228:231], v8 offset:34816
    v_mfma_f32_16x16x32_bf16 v[208:211], v[48:51], v[236:239], v[208:211]
    ds_read_b64_tr_b16 v[32:33], v24 offset:16384
    ds_read_b64_tr_b16 v[34:35], v24 offset:16896
    s_waitcnt lgkmcnt(8)
    v_mfma_f32_16x16x32_bf16 v[196:199], v[52:55], v[232:235], v[196:199]
    ds_read_b64_tr_b16 v[36:37], v25 offset:16384
    ds_read_b64_tr_b16 v[38:39], v25 offset:16896
    v_mfma_f32_16x16x32_bf16 v[212:215], v[52:55], v[236:239], v[212:215]
    ds_read_b64_tr_b16 v[40:41], v26 offset:16384
    s_waitcnt lgkmcnt(9)
    v_mfma_f32_16x16x32_bf16 v[200:203], v[56:59], v[232:235], v[200:203]
    ds_read_b64_tr_b16 v[42:43], v26 offset:16896
    v_mfma_f32_16x16x32_bf16 v[216:219], v[56:59], v[236:239], v[216:219]
    ds_read_b64_tr_b16 v[44:45], v27 offset:16384
    s_waitcnt lgkmcnt(9)
    v_mfma_f32_16x16x32_bf16 v[204:207], v[60:63], v[232:235], v[204:207]
    ds_read_b64_tr_b16 v[46:47], v27 offset:16896
    v_mfma_f32_16x16x32_bf16 v[220:223], v[60:63], v[236:239], v[220:223]
    s_waitcnt lgkmcnt(6)
    v_mfma_f32_16x16x32_bf16 v[192:195], v[32:35], v[224:227], v[192:195]
    ds_read_b128 v[232:235], v9 offset:32768
    ds_read_b128 v[236:239], v9 offset:34816
    v_mfma_f32_16x16x32_bf16 v[208:211], v[32:35], v[228:231], v[208:211]
    ds_read_b64_tr_b16 v[48:49], v24 offset:20480
    ds_read_b64_tr_b16 v[50:51], v24 offset:20992
    s_waitcnt lgkmcnt(8)
    v_mfma_f32_16x16x32_bf16 v[196:199], v[36:39], v[224:227], v[196:199]
    ds_read_b64_tr_b16 v[52:53], v25 offset:20480
    ds_read_b64_tr_b16 v[54:55], v25 offset:20992
    v_mfma_f32_16x16x32_bf16 v[212:215], v[36:39], v[228:231], v[212:215]
    ds_read_b64_tr_b16 v[56:57], v26 offset:20480
    s_waitcnt lgkmcnt(9)
    v_mfma_f32_16x16x32_bf16 v[200:203], v[40:43], v[224:227], v[200:203]
    ds_read_b64_tr_b16 v[58:59], v26 offset:20992
    v_mfma_f32_16x16x32_bf16 v[216:219], v[40:43], v[228:231], v[216:219]
    ds_read_b64_tr_b16 v[60:61], v27 offset:20480
    s_waitcnt lgkmcnt(9)
    v_mfma_f32_16x16x32_bf16 v[204:207], v[44:47], v[224:227], v[204:207]
    ds_read_b64_tr_b16 v[62:63], v27 offset:20992
    v_mfma_f32_16x16x32_bf16 v[220:223], v[44:47], v[228:231], v[220:223]
    s_waitcnt lgkmcnt(6)
    v_mfma_f32_16x16x32_bf16 v[192:195], v[48:51], v[232:235], v[192:195]
    ds_read_b128 v[224:227], v8 offset:49152
    ds_read_b128 v[228:231], v8 offset:51200
    v_mfma_f32_16x16x32_bf16 v[208:211], v[48:51], v[236:239], v[208:211]
    ds_read_b64_tr_b16 v[32:33], v24 offset:24576
    ds_read_b64_tr_b16 v[34:35], v24 offset:25088
    s_waitcnt lgkmcnt(8)
    v_mfma_f32_16x16x32_bf16 v[196:199], v[52:55], v[232:235], v[196:199]
    ds_read_b64_tr_b16 v[36:37], v25 offset:24576
    ds_read_b64_tr_b16 v[38:39], v25 offset:25088
    v_mfma_f32_16x16x32_bf16 v[212:215], v[52:55], v[236:239], v[212:215]
    ds_read_b64_tr_b16 v[40:41], v26 offset:24576
    s_waitcnt lgkmcnt(9)
    v_mfma_f32_16x16x32_bf16 v[200:203], v[56:59], v[232:235], v[200:203]
    ds_read_b64_tr_b16 v[42:43], v26 offset:25088
    v_mfma_f32_16x16x32_bf16 v[216:219], v[56:59], v[236:239], v[216:219]
    ds_read_b64_tr_b16 v[44:45], v27 offset:24576
    s_waitcnt lgkmcnt(9)
    v_mfma_f32_16x16x32_bf16 v[204:207], v[60:63], v[232:235], v[204:207]
    ds_read_b64_tr_b16 v[46:47], v27 offset:25088
    v_mfma_f32_16x16x32_bf16 v[220:223], v[60:63], v[236:239], v[220:223]
    s_waitcnt lgkmcnt(6)
    v_mfma_f32_16x16x32_bf16 v[192:195], v[32:35], v[224:227], v[192:195]
    ds_read_b128 v[232:235], v9 offset:49152
    ds_read_b128 v[236:239], v9 offset:51200
    v_mfma_f32_16x16x32_bf16 v[208:211], v[32:35], v[228:231], v[208:211]
    ds_read_b64_tr_b16 v[48:49], v24 offset:28672
    ds_read_b64_tr_b16 v[50:51], v24 offset:29184
    s_waitcnt lgkmcnt(8)
    v_mfma_f32_16x16x32_bf16 v[196:199], v[36:39], v[224:227], v[196:199]
    ds_read_b64_tr_b16 v[52:53], v25 offset:28672
    ds_read_b64_tr_b16 v[54:55], v25 offset:29184
    v_mfma_f32_16x16x32_bf16 v[212:215], v[36:39], v[228:231], v[212:215]
    ds_read_b64_tr_b16 v[56:57], v26 offset:28672
    s_waitcnt lgkmcnt(9)
    v_mfma_f32_16x16x32_bf16 v[200:203], v[40:43], v[224:227], v[200:203]
    ds_read_b64_tr_b16 v[58:59], v26 offset:29184
    v_mfma_f32_16x16x32_bf16 v[216:219], v[40:43], v[228:231], v[216:219]
    ds_read_b64_tr_b16 v[60:61], v27 offset:28672
    s_waitcnt lgkmcnt(9)
    v_mfma_f32_16x16x32_bf16 v[204:207], v[44:47], v[224:227], v[204:207]
    ds_read_b64_tr_b16 v[62:63], v27 offset:29184
    v_mfma_f32_16x16x32_bf16 v[220:223], v[44:47], v[228:231], v[220:223]
    s_waitcnt lgkmcnt(6)
    v_mfma_f32_16x16x32_bf16 v[192:195], v[48:51], v[232:235], v[192:195]
    ds_read_b64_tr_b16 v[32:33], v10 offset:0
    ds_read_b64_tr_b16 v[34:35], v10 offset:512
    v_mfma_f32_16x16x32_bf16 v[208:211], v[48:51], v[236:239], v[208:211]
    ds_read_b64_tr_b16 v[36:37], v11 offset:0
    s_waitcnt lgkmcnt(7)
    v_mfma_f32_16x16x32_bf16 v[196:199], v[52:55], v[232:235], v[196:199]
    ds_read_b64_tr_b16 v[38:39], v11 offset:512
    v_mfma_f32_16x16x32_bf16 v[212:215], v[52:55], v[236:239], v[212:215]
    ds_read_b64_tr_b16 v[40:41], v12 offset:0
    s_waitcnt lgkmcnt(7)
    v_mfma_f32_16x16x32_bf16 v[200:203], v[56:59], v[232:235], v[200:203]
    ds_read_b64_tr_b16 v[42:43], v12 offset:512
    v_mfma_f32_16x16x32_bf16 v[216:219], v[56:59], v[236:239], v[216:219]
    ds_read_b64_tr_b16 v[44:45], v13 offset:0
    s_waitcnt lgkmcnt(7)
    v_mfma_f32_16x16x32_bf16 v[204:207], v[60:63], v[232:235], v[204:207]
    ds_read_b64_tr_b16 v[46:47], v13 offset:512
    v_mfma_f32_16x16x32_bf16 v[220:223], v[60:63], v[236:239], v[220:223]
    s_waitcnt lgkmcnt(6)
    v_mfma_f32_16x16x32_bf16 v[192:195], v[32:35], v[64:67], v[192:195]
    ds_read_b64_tr_b16 v[48:49], v10 offset:4096
    ds_read_b64_tr_b16 v[50:51], v10 offset:4608
    v_mfma_f32_16x16x32_bf16 v[208:211], v[32:35], v[68:71], v[208:211]
    ds_read_b64_tr_b16 v[52:53], v11 offset:4096
    s_waitcnt lgkmcnt(7)
    v_mfma_f32_16x16x32_bf16 v[196:199], v[36:39], v[64:67], v[196:199]
    ds_read_b64_tr_b16 v[54:55], v11 offset:4608
    v_mfma_f32_16x16x32_bf16 v[212:215], v[36:39], v[68:71], v[212:215]
    ds_read_b64_tr_b16 v[56:57], v12 offset:4096
    s_waitcnt lgkmcnt(7)
    v_mfma_f32_16x16x32_bf16 v[200:203], v[40:43], v[64:67], v[200:203]
    ds_read_b64_tr_b16 v[58:59], v12 offset:4608
    v_mfma_f32_16x16x32_bf16 v[216:219], v[40:43], v[68:71], v[216:219]
    ds_read_b64_tr_b16 v[60:61], v13 offset:4096
    s_waitcnt lgkmcnt(7)
    v_mfma_f32_16x16x32_bf16 v[204:207], v[44:47], v[64:67], v[204:207]
    ds_read_b64_tr_b16 v[62:63], v13 offset:4608
    v_mfma_f32_16x16x32_bf16 v[220:223], v[44:47], v[68:71], v[220:223]
    s_waitcnt lgkmcnt(6)
    v_mfma_f32_16x16x32_bf16 v[192:195], v[48:51], v[72:75], v[192:195]
    s_waitcnt lgkmcnt(0)
    s_waitcnt vmcnt(0)
    s_barrier
    ds_read_b64_tr_b16 v[32:33], v10 offset:16384
    ds_read_b64_tr_b16 v[34:35], v10 offset:16896
    v_mfma_f32_16x16x32_bf16 v[208:211], v[48:51], v[76:79], v[208:211]
    ds_read_b64_tr_b16 v[36:37], v11 offset:16384
    v_mfma_f32_16x16x32_bf16 v[196:199], v[52:55], v[72:75], v[196:199]
    ds_read_b64_tr_b16 v[38:39], v11 offset:16896
    v_mfma_f32_16x16x32_bf16 v[212:215], v[52:55], v[76:79], v[212:215]
    ds_read_b64_tr_b16 v[40:41], v12 offset:16384
    v_mfma_f32_16x16x32_bf16 v[200:203], v[56:59], v[72:75], v[200:203]
    ds_read_b64_tr_b16 v[42:43], v12 offset:16896
    v_mfma_f32_16x16x32_bf16 v[216:219], v[56:59], v[76:79], v[216:219]
    ds_read_b64_tr_b16 v[44:45], v13 offset:16384
    v_mfma_f32_16x16x32_bf16 v[204:207], v[60:63], v[72:75], v[204:207]
    ds_read_b64_tr_b16 v[46:47], v13 offset:16896
    v_mfma_f32_16x16x32_bf16 v[220:223], v[60:63], v[76:79], v[220:223]
    s_waitcnt lgkmcnt(6)
    v_mfma_f32_16x16x32_bf16 v[192:195], v[32:35], v[80:83], v[192:195]
    ds_read_b64_tr_b16 v[48:49], v10 offset:20480
    ds_read_b64_tr_b16 v[50:51], v10 offset:20992
    v_mfma_f32_16x16x32_bf16 v[208:211], v[32:35], v[84:87], v[208:211]
    ds_read_b64_tr_b16 v[52:53], v11 offset:20480
    s_waitcnt lgkmcnt(7)
    v_mfma_f32_16x16x32_bf16 v[196:199], v[36:39], v[80:83], v[196:199]
    ds_read_b64_tr_b16 v[54:55], v11 offset:20992
    v_mfma_f32_16x16x32_bf16 v[212:215], v[36:39], v[84:87], v[212:215]
    ds_read_b64_tr_b16 v[56:57], v12 offset:20480
    s_waitcnt lgkmcnt(7)
    v_mfma_f32_16x16x32_bf16 v[200:203], v[40:43], v[80:83], v[200:203]
    ds_read_b64_tr_b16 v[58:59], v12 offset:20992
    v_mfma_f32_16x16x32_bf16 v[216:219], v[40:43], v[84:87], v[216:219]
    ds_read_b64_tr_b16 v[60:61], v13 offset:20480
    s_waitcnt lgkmcnt(7)
    v_mfma_f32_16x16x32_bf16 v[204:207], v[44:47], v[80:83], v[204:207]
    ds_read_b64_tr_b16 v[62:63], v13 offset:20992
    v_mfma_f32_16x16x32_bf16 v[220:223], v[44:47], v[84:87], v[220:223]
    s_waitcnt lgkmcnt(6)
    v_mfma_f32_16x16x32_bf16 v[192:195], v[48:51], v[88:91], v[192:195]
    ds_read_b64_tr_b16 v[32:33], v10 offset:32768
    ds_read_b64_tr_b16 v[34:35], v10 offset:33280
    v_mfma_f32_16x16x32_bf16 v[208:211], v[48:51], v[92:95], v[208:211]
    ds_read_b64_tr_b16 v[36:37], v11 offset:32768
    s_waitcnt lgkmcnt(7)
    v_mfma_f32_16x16x32_bf16 v[196:199], v[52:55], v[88:91], v[196:199]
    ds_read_b64_tr_b16 v[38:39], v11 offset:33280
    v_mfma_f32_16x16x32_bf16 v[212:215], v[52:55], v[92:95], v[212:215]
    ds_read_b64_tr_b16 v[40:41], v12 offset:32768
    s_waitcnt lgkmcnt(7)
    v_mfma_f32_16x16x32_bf16 v[200:203], v[56:59], v[88:91], v[200:203]
    ds_read_b64_tr_b16 v[42:43], v12 offset:33280
    v_mfma_f32_16x16x32_bf16 v[216:219], v[56:59], v[92:95], v[216:219]
    ds_read_b64_tr_b16 v[44:45], v13 offset:32768
    s_waitcnt lgkmcnt(7)
    v_mfma_f32_16x16x32_bf16 v[204:207], v[60:63], v[88:91], v[204:207]
    ds_read_b64_tr_b16 v[46:47], v13 offset:33280
    v_mfma_f32_16x16x32_bf16 v[220:223], v[60:63], v[92:95], v[220:223]
    s_waitcnt lgkmcnt(6)
    v_mfma_f32_16x16x32_bf16 v[192:195], v[32:35], v[96:99], v[192:195]
    ds_read_b64_tr_b16 v[48:49], v10 offset:36864
    ds_read_b64_tr_b16 v[50:51], v10 offset:37376
    v_mfma_f32_16x16x32_bf16 v[208:211], v[32:35], v[100:103], v[208:211]
    ds_read_b64_tr_b16 v[52:53], v11 offset:36864
    s_waitcnt lgkmcnt(7)
    v_mfma_f32_16x16x32_bf16 v[196:199], v[36:39], v[96:99], v[196:199]
    ds_read_b64_tr_b16 v[54:55], v11 offset:37376
    v_mfma_f32_16x16x32_bf16 v[212:215], v[36:39], v[100:103], v[212:215]
    ds_read_b64_tr_b16 v[56:57], v12 offset:36864
    s_waitcnt lgkmcnt(7)
    v_mfma_f32_16x16x32_bf16 v[200:203], v[40:43], v[96:99], v[200:203]
    ds_read_b64_tr_b16 v[58:59], v12 offset:37376
    v_mfma_f32_16x16x32_bf16 v[216:219], v[40:43], v[100:103], v[216:219]
    ds_read_b64_tr_b16 v[60:61], v13 offset:36864
    s_waitcnt lgkmcnt(7)
    v_mfma_f32_16x16x32_bf16 v[204:207], v[44:47], v[96:99], v[204:207]
    ds_read_b64_tr_b16 v[62:63], v13 offset:37376
    v_mfma_f32_16x16x32_bf16 v[220:223], v[44:47], v[100:103], v[220:223]
    s_waitcnt lgkmcnt(6)
    v_mfma_f32_16x16x32_bf16 v[192:195], v[48:51], v[104:107], v[192:195]
    ds_read_b64_tr_b16 v[32:33], v10 offset:49152
    ds_read_b64_tr_b16 v[34:35], v10 offset:49664
    v_mfma_f32_16x16x32_bf16 v[208:211], v[48:51], v[108:111], v[208:211]
    ds_read_b64_tr_b16 v[36:37], v11 offset:49152
    s_waitcnt lgkmcnt(7)
    v_mfma_f32_16x16x32_bf16 v[196:199], v[52:55], v[104:107], v[196:199]
    ds_read_b64_tr_b16 v[38:39], v11 offset:49664
    v_mfma_f32_16x16x32_bf16 v[212:215], v[52:55], v[108:111], v[212:215]
    ds_read_b64_tr_b16 v[40:41], v12 offset:49152
    s_waitcnt lgkmcnt(7)
    v_mfma_f32_16x16x32_bf16 v[200:203], v[56:59], v[104:107], v[200:203]
    ds_read_b64_tr_b16 v[42:43], v12 offset:49664
    v_mfma_f32_16x16x32_bf16 v[216:219], v[56:59], v[108:111], v[216:219]
    ds_read_b64_tr_b16 v[44:45], v13 offset:49152
    s_waitcnt lgkmcnt(7)
    v_mfma_f32_16x16x32_bf16 v[204:207], v[60:63], v[104:107], v[204:207]
    ds_read_b64_tr_b16 v[46:47], v13 offset:49664
    v_mfma_f32_16x16x32_bf16 v[220:223], v[60:63], v[108:111], v[220:223]
    s_waitcnt lgkmcnt(6)
    v_mfma_f32_16x16x32_bf16 v[192:195], v[32:35], v[112:115], v[192:195]
    ds_read_b64_tr_b16 v[48:49], v10 offset:53248
    ds_read_b64_tr_b16 v[50:51], v10 offset:53760
    v_mfma_f32_16x16x32_bf16 v[208:211], v[32:35], v[116:119], v[208:211]
    ds_read_b64_tr_b16 v[52:53], v11 offset:53248
    s_waitcnt lgkmcnt(7)
    v_mfma_f32_16x16x32_bf16 v[196:199], v[36:39], v[112:115], v[196:199]
    ds_read_b64_tr_b16 v[54:55], v11 offset:53760
    v_mfma_f32_16x16x32_bf16 v[212:215], v[36:39], v[116:119], v[212:215]
    ds_read_b64_tr_b16 v[56:57], v12 offset:53248
    s_waitcnt lgkmcnt(7)
    v_mfma_f32_16x16x32_bf16 v[200:203], v[40:43], v[112:115], v[200:203]
    ds_read_b64_tr_b16 v[58:59], v12 offset:53760
    v_mfma_f32_16x16x32_bf16 v[216:219], v[40:43], v[116:119], v[216:219]
    ds_read_b64_tr_b16 v[60:61], v13 offset:53248
    s_waitcnt lgkmcnt(7)
    v_mfma_f32_16x16x32_bf16 v[204:207], v[44:47], v[112:115], v[204:207]
    ds_read_b64_tr_b16 v[62:63], v13 offset:53760
    v_mfma_f32_16x16x32_bf16 v[220:223], v[44:47], v[116:119], v[220:223]
    s_waitcnt lgkmcnt(6)
    v_mfma_f32_16x16x32_bf16 v[192:195], v[48:51], v[120:123], v[192:195]
    ds_read_b64_tr_b16 v[32:33], v10 offset:8192
    ds_read_b64_tr_b16 v[34:35], v10 offset:8704
    v_mfma_f32_16x16x32_bf16 v[208:211], v[48:51], v[124:127], v[208:211]
    ds_read_b64_tr_b16 v[36:37], v11 offset:8192
    s_waitcnt lgkmcnt(7)
    v_mfma_f32_16x16x32_bf16 v[196:199], v[52:55], v[120:123], v[196:199]
    ds_read_b64_tr_b16 v[38:39], v11 offset:8704
    v_mfma_f32_16x16x32_bf16 v[212:215], v[52:55], v[124:127], v[212:215]
    ds_read_b64_tr_b16 v[40:41], v12 offset:8192
    s_waitcnt lgkmcnt(7)
    v_mfma_f32_16x16x32_bf16 v[200:203], v[56:59], v[120:123], v[200:203]
    ds_read_b64_tr_b16 v[42:43], v12 offset:8704
    v_mfma_f32_16x16x32_bf16 v[216:219], v[56:59], v[124:127], v[216:219]
    ds_read_b64_tr_b16 v[44:45], v13 offset:8192
    s_waitcnt lgkmcnt(7)
    v_mfma_f32_16x16x32_bf16 v[204:207], v[60:63], v[120:123], v[204:207]
    ds_read_b64_tr_b16 v[46:47], v13 offset:8704
    v_mfma_f32_16x16x32_bf16 v[220:223], v[60:63], v[124:127], v[220:223]
    s_waitcnt lgkmcnt(6)
    v_mfma_f32_16x16x32_bf16 v[192:195], v[32:35], v[128:131], v[192:195]
    ds_read_b64_tr_b16 v[48:49], v10 offset:12288
    ds_read_b64_tr_b16 v[50:51], v10 offset:12800
    v_mfma_f32_16x16x32_bf16 v[208:211], v[32:35], v[132:135], v[208:211]
    ds_read_b64_tr_b16 v[52:53], v11 offset:12288
    s_waitcnt lgkmcnt(7)
    v_mfma_f32_16x16x32_bf16 v[196:199], v[36:39], v[128:131], v[196:199]
    ds_read_b64_tr_b16 v[54:55], v11 offset:12800
    v_mfma_f32_16x16x32_bf16 v[212:215], v[36:39], v[132:135], v[212:215]
    ds_read_b64_tr_b16 v[56:57], v12 offset:12288
    s_waitcnt lgkmcnt(7)
    v_mfma_f32_16x16x32_bf16 v[200:203], v[40:43], v[128:131], v[200:203]
    ds_read_b64_tr_b16 v[58:59], v12 offset:12800
    v_mfma_f32_16x16x32_bf16 v[216:219], v[40:43], v[132:135], v[216:219]
    ds_read_b64_tr_b16 v[60:61], v13 offset:12288
    s_waitcnt lgkmcnt(7)
    v_mfma_f32_16x16x32_bf16 v[204:207], v[44:47], v[128:131], v[204:207]
    ds_read_b64_tr_b16 v[62:63], v13 offset:12800
    v_mfma_f32_16x16x32_bf16 v[220:223], v[44:47], v[132:135], v[220:223]
    s_waitcnt lgkmcnt(6)
    v_mfma_f32_16x16x32_bf16 v[192:195], v[48:51], v[136:139], v[192:195]
    ds_read_b64_tr_b16 v[32:33], v10 offset:24576
    ds_read_b64_tr_b16 v[34:35], v10 offset:25088
    v_mfma_f32_16x16x32_bf16 v[208:211], v[48:51], v[140:143], v[208:211]
    ds_read_b64_tr_b16 v[36:37], v11 offset:24576
    s_waitcnt lgkmcnt(7)
    v_mfma_f32_16x16x32_bf16 v[196:199], v[52:55], v[136:139], v[196:199]
    ds_read_b64_tr_b16 v[38:39], v11 offset:25088
    v_mfma_f32_16x16x32_bf16 v[212:215], v[52:55], v[140:143], v[212:215]
    ds_read_b64_tr_b16 v[40:41], v12 offset:24576
    s_waitcnt lgkmcnt(7)
    v_mfma_f32_16x16x32_bf16 v[200:203], v[56:59], v[136:139], v[200:203]
    ds_read_b64_tr_b16 v[42:43], v12 offset:25088
    v_mfma_f32_16x16x32_bf16 v[216:219], v[56:59], v[140:143], v[216:219]
    ds_read_b64_tr_b16 v[44:45], v13 offset:24576
    s_waitcnt lgkmcnt(7)
    v_mfma_f32_16x16x32_bf16 v[204:207], v[60:63], v[136:139], v[204:207]
    ds_read_b64_tr_b16 v[46:47], v13 offset:25088
    v_mfma_f32_16x16x32_bf16 v[220:223], v[60:63], v[140:143], v[220:223]
    s_waitcnt lgkmcnt(6)
    v_mfma_f32_16x16x32_bf16 v[192:195], v[32:35], v[144:147], v[192:195]
    ds_read_b64_tr_b16 v[48:49], v10 offset:28672
    ds_read_b64_tr_b16 v[50:51], v10 offset:29184
    v_mfma_f32_16x16x32_bf16 v[208:211], v[32:35], v[148:151], v[208:211]
    ds_read_b64_tr_b16 v[52:53], v11 offset:28672
    s_waitcnt lgkmcnt(7)
    v_mfma_f32_16x16x32_bf16 v[196:199], v[36:39], v[144:147], v[196:199]
    ds_read_b64_tr_b16 v[54:55], v11 offset:29184
    v_mfma_f32_16x16x32_bf16 v[212:215], v[36:39], v[148:151], v[212:215]
    ds_read_b64_tr_b16 v[56:57], v12 offset:28672
    s_waitcnt lgkmcnt(7)
    v_mfma_f32_16x16x32_bf16 v[200:203], v[40:43], v[144:147], v[200:203]
    ds_read_b64_tr_b16 v[58:59], v12 offset:29184
    v_mfma_f32_16x16x32_bf16 v[216:219], v[40:43], v[148:151], v[216:219]
    ds_read_b64_tr_b16 v[60:61], v13 offset:28672
    s_waitcnt lgkmcnt(7)
    v_mfma_f32_16x16x32_bf16 v[204:207], v[44:47], v[144:147], v[204:207]
    ds_read_b64_tr_b16 v[62:63], v13 offset:29184
    v_mfma_f32_16x16x32_bf16 v[220:223], v[44:47], v[148:151], v[220:223]
    s_waitcnt lgkmcnt(6)
    v_mfma_f32_16x16x32_bf16 v[192:195], v[48:51], v[152:155], v[192:195]
    ds_read_b64_tr_b16 v[32:33], v10 offset:40960
    ds_read_b64_tr_b16 v[34:35], v10 offset:41472
    v_mfma_f32_16x16x32_bf16 v[208:211], v[48:51], v[156:159], v[208:211]
    ds_read_b64_tr_b16 v[36:37], v11 offset:40960
    s_waitcnt lgkmcnt(7)
    v_mfma_f32_16x16x32_bf16 v[196:199], v[52:55], v[152:155], v[196:199]
    ds_read_b64_tr_b16 v[38:39], v11 offset:41472
    v_mfma_f32_16x16x32_bf16 v[212:215], v[52:55], v[156:159], v[212:215]
    ds_read_b64_tr_b16 v[40:41], v12 offset:40960
    s_waitcnt lgkmcnt(7)
    v_mfma_f32_16x16x32_bf16 v[200:203], v[56:59], v[152:155], v[200:203]
    ds_read_b64_tr_b16 v[42:43], v12 offset:41472
    v_mfma_f32_16x16x32_bf16 v[216:219], v[56:59], v[156:159], v[216:219]
    ds_read_b64_tr_b16 v[44:45], v13 offset:40960
    s_waitcnt lgkmcnt(7)
    v_mfma_f32_16x16x32_bf16 v[204:207], v[60:63], v[152:155], v[204:207]
    ds_read_b64_tr_b16 v[46:47], v13 offset:41472
    v_mfma_f32_16x16x32_bf16 v[220:223], v[60:63], v[156:159], v[220:223]
    s_waitcnt lgkmcnt(6)
    v_mfma_f32_16x16x32_bf16 v[192:195], v[32:35], v[160:163], v[192:195]
    ds_read_b64_tr_b16 v[48:49], v10 offset:45056
    ds_read_b64_tr_b16 v[50:51], v10 offset:45568
    v_mfma_f32_16x16x32_bf16 v[208:211], v[32:35], v[164:167], v[208:211]
    ds_read_b64_tr_b16 v[52:53], v11 offset:45056
    s_waitcnt lgkmcnt(7)
    v_mfma_f32_16x16x32_bf16 v[196:199], v[36:39], v[160:163], v[196:199]
    ds_read_b64_tr_b16 v[54:55], v11 offset:45568
    v_mfma_f32_16x16x32_bf16 v[212:215], v[36:39], v[164:167], v[212:215]
    ds_read_b64_tr_b16 v[56:57], v12 offset:45056
    s_waitcnt lgkmcnt(7)
    v_mfma_f32_16x16x32_bf16 v[200:203], v[40:43], v[160:163], v[200:203]
    ds_read_b64_tr_b16 v[58:59], v12 offset:45568
    v_mfma_f32_16x16x32_bf16 v[216:219], v[40:43], v[164:167], v[216:219]
    ds_read_b64_tr_b16 v[60:61], v13 offset:45056
    s_waitcnt lgkmcnt(7)
    v_mfma_f32_16x16x32_bf16 v[204:207], v[44:47], v[160:163], v[204:207]
    ds_read_b64_tr_b16 v[62:63], v13 offset:45568
    v_mfma_f32_16x16x32_bf16 v[220:223], v[44:47], v[164:167], v[220:223]
    s_waitcnt lgkmcnt(6)
    v_mfma_f32_16x16x32_bf16 v[192:195], v[48:51], v[168:171], v[192:195]
    ds_read_b64_tr_b16 v[32:33], v10 offset:57344
    ds_read_b64_tr_b16 v[34:35], v10 offset:57856
    v_mfma_f32_16x16x32_bf16 v[208:211], v[48:51], v[172:175], v[208:211]
    ds_read_b64_tr_b16 v[36:37], v11 offset:57344
    s_waitcnt lgkmcnt(7)
    v_mfma_f32_16x16x32_bf16 v[196:199], v[52:55], v[168:171], v[196:199]
    ds_read_b64_tr_b16 v[38:39], v11 offset:57856
    v_mfma_f32_16x16x32_bf16 v[212:215], v[52:55], v[172:175], v[212:215]
    ds_read_b64_tr_b16 v[40:41], v12 offset:57344
    s_waitcnt lgkmcnt(7)
    v_mfma_f32_16x16x32_bf16 v[200:203], v[56:59], v[168:171], v[200:203]
    ds_read_b64_tr_b16 v[42:43], v12 offset:57856
    v_mfma_f32_16x16x32_bf16 v[216:219], v[56:59], v[172:175], v[216:219]
    ds_read_b64_tr_b16 v[44:45], v13 offset:57344
    s_waitcnt lgkmcnt(7)
    v_mfma_f32_16x16x32_bf16 v[204:207], v[60:63], v[168:171], v[204:207]
    ds_read_b64_tr_b16 v[46:47], v13 offset:57856
    v_mfma_f32_16x16x32_bf16 v[220:223], v[60:63], v[172:175], v[220:223]
    s_waitcnt lgkmcnt(6)
    v_mfma_f32_16x16x32_bf16 v[192:195], v[32:35], v[176:179], v[192:195]
    ds_read_b64_tr_b16 v[48:49], v10 offset:61440
    ds_read_b64_tr_b16 v[50:51], v10 offset:61952
    v_mfma_f32_16x16x32_bf16 v[208:211], v[32:35], v[180:183], v[208:211]
    ds_read_b64_tr_b16 v[52:53], v11 offset:61440
    s_waitcnt lgkmcnt(7)
    v_mfma_f32_16x16x32_bf16 v[196:199], v[36:39], v[176:179], v[196:199]
    ds_read_b64_tr_b16 v[54:55], v11 offset:61952
    v_mfma_f32_16x16x32_bf16 v[212:215], v[36:39], v[180:183], v[212:215]
    ds_read_b64_tr_b16 v[56:57], v12 offset:61440
    s_waitcnt lgkmcnt(7)
    v_mfma_f32_16x16x32_bf16 v[200:203], v[40:43], v[176:179], v[200:203]
    ds_read_b64_tr_b16 v[58:59], v12 offset:61952
    v_mfma_f32_16x16x32_bf16 v[216:219], v[40:43], v[180:183], v[216:219]
    ds_read_b64_tr_b16 v[60:61], v13 offset:61440
    s_waitcnt lgkmcnt(7)
    v_mfma_f32_16x16x32_bf16 v[204:207], v[44:47], v[176:179], v[204:207]
    ds_read_b64_tr_b16 v[62:63], v13 offset:61952
    v_mfma_f32_16x16x32_bf16 v[220:223], v[44:47], v[180:183], v[220:223]
    s_waitcnt lgkmcnt(6)
    v_mfma_f32_16x16x32_bf16 v[192:195], v[48:51], v[184:187], v[192:195]
    v_mfma_f32_16x16x32_bf16 v[208:211], v[48:51], v[188:191], v[208:211]
    s_waitcnt lgkmcnt(4)
    v_mfma_f32_16x16x32_bf16 v[196:199], v[52:55], v[184:187], v[196:199]
    v_mfma_f32_16x16x32_bf16 v[212:215], v[52:55], v[188:191], v[212:215]
    s_waitcnt lgkmcnt(2)
    v_mfma_f32_16x16x32_bf16 v[200:203], v[56:59], v[184:187], v[200:203]
    v_mfma_f32_16x16x32_bf16 v[216:219], v[56:59], v[188:191], v[216:219]
    s_waitcnt lgkmcnt(0)
    v_mfma_f32_16x16x32_bf16 v[204:207], v[60:63], v[184:187], v[204:207]
    v_mfma_f32_16x16x32_bf16 v[220:223], v[60:63], v[188:191], v[220:223]
    s_lshl_b32 s32, s30, 10
    v_add_u32 v14, s32, v1
    v_mov_b32 v28, 0x3e8293ee
    v_mov_b32 v29, 0x3e8293ee
    s_nop 2
    v_pk_mul_f32 v[192:193], v[192:193], v[28:29]
    v_pk_mul_f32 v[194:195], v[194:195], v[28:29]
    v_pk_mul_f32 v[196:197], v[196:197], v[28:29]
    v_pk_mul_f32 v[198:199], v[198:199], v[28:29]
    v_pk_mul_f32 v[200:201], v[200:201], v[28:29]
    v_pk_mul_f32 v[202:203], v[202:203], v[28:29]
    v_pk_mul_f32 v[204:205], v[204:205], v[28:29]
    v_pk_mul_f32 v[206:207], v[206:207], v[28:29]
    v_pk_mul_f32 v[208:209], v[208:209], v[28:29]
    v_pk_mul_f32 v[210:211], v[210:211], v[28:29]
    v_pk_mul_f32 v[212:213], v[212:213], v[28:29]
    v_pk_mul_f32 v[214:215], v[214:215], v[28:29]
    v_pk_mul_f32 v[216:217], v[216:217], v[28:29]
    v_pk_mul_f32 v[218:219], v[218:219], v[28:29]
    v_pk_mul_f32 v[220:221], v[220:221], v[28:29]
    v_pk_mul_f32 v[222:223], v[222:223], v[28:29]
    v_cvt_pk_bf16_f32 v32, v192, v193
    v_cvt_pk_bf16_f32 v33, v194, v195
    v_cvt_pk_bf16_f32 v34, v196, v197
    v_cvt_pk_bf16_f32 v35, v198, v199
    v_cvt_pk_bf16_f32 v16, v208, v209
    v_cvt_pk_bf16_f32 v17, v210, v211
    v_cvt_pk_bf16_f32 v18, v212, v213
    v_cvt_pk_bf16_f32 v19, v214, v215
    ds_write_b128 v14, v[32:35] offset:0
    v_cvt_pk_bf16_f32 v36, v200, v201
    v_cvt_pk_bf16_f32 v37, v202, v203
    v_cvt_pk_bf16_f32 v38, v204, v205
    v_cvt_pk_bf16_f32 v39, v206, v207
    v_cvt_pk_bf16_f32 v20, v216, v217
    v_cvt_pk_bf16_f32 v21, v218, v219
    v_cvt_pk_bf16_f32 v22, v220, v221
    v_cvt_pk_bf16_f32 v23, v222, v223
    ds_write_b128 v14, v[36:39] offset:4096
    s_and_b32 s56, s27, 3
    s_lshl_b32 s56, s56, 2
    s_and_b32 s29, s28, 3
    s_add_u32 s56, s56, s29
    s_lshr_b32 s57, s27, 2
    s_lshl_b32 s57, s57, 3
    s_lshr_b32 s29, s28, 2
    s_add_u32 s57, s57, s29
    v_lshrrev_b32 v4, 3, v0
    v_and_b32 v5, 7, v0
    v_lshrrev_b32 v6, 4, v0
    v_lshlrev_b32 v6, 1, v6
    v_xor_b32 v6, v6, v5
    v_lshlrev_b32 v6, 4, v6
    v_lshlrev_b32 v10, 11, v4
    v_add_u32 v10, v10, v6
    s_lshl_b32 s30, s57, 7
    v_add_u32 v10, s30, v10
    s_lshl_b32 s61, s24, 10
    s_and_b32 s60, s24, 3
    s_lshl_b32 s60, s60, 14
    s_and_b32 s101, s57, 7
    s_lshr_b32 s100, s24, 2
    s_add_u32 s100, s100, s101
    s_waitcnt lgkmcnt(0)
    v_and_b32 v2, 15, v0
    v_lshrrev_b32 v3, 4, v0
    v_lshlrev_b32 v3, 2, v3
    v_sub_u32 v4, v2, v3
    v_mov_b32 v5, 0xf149f2ca
    v_cmp_le_i32 vcc, 0, v4
    s_nop 1
    v_cndmask_b32_e64 v28, v5, 0, vcc
    v_cndmask_b32_e64 v24, 0, v5, vcc
    v_cmp_le_i32 vcc, 1, v4
    s_nop 1
    v_cndmask_b32_e64 v29, v5, 0, vcc
    v_cndmask_b32_e64 v25, 0, v5, vcc
    v_cmp_le_i32 vcc, 2, v4
    s_nop 1
    v_cndmask_b32_e64 v30, v5, 0, vcc
    v_cndmask_b32_e64 v26, 0, v5, vcc
    v_cmp_le_i32 vcc, 3, v4
    s_nop 1
    v_cndmask_b32_e64 v31, v5, 0, vcc
    v_cndmask_b32_e64 v27, 0, v5, vcc
    v_mov_b32 v32, 0x3f803f80
    v_mov_b32 v33, 0x3f803f80
    v_mov_b32 v34, 0x3f803f80
    v_mov_b32 v35, 0x3f803f80
    s_and_b32 s31, s24, 3
    s_lshl_b32 s31, s31, 1
    s_lshr_b32 s32, s24, 2
    s_add_u32 s31, s31, s32
    s_lshl_b32 s36, s31, 10
    v_add_u32 v6, s36, v1
    v_lshlrev_b32 v7, 3, v0
    v_add_u32 v7, s36, v7
    v_add_u32 v6, 0x10000, v6
    v_add_u32 v7, 0x16000, v7
    v_add_u32 v8, s61, v1
    s_lshl_b32 s37, s25, 3
    s_add_u32 s37, s37, s31
    s_lshl_b32 s37, s37, 5
    s_lshl_b32 s38, s26, 1
    s_add_u32 s37, s37, s38
    s_lshl_b32 s37, s37, 10
    s_add_u32 s37, s37, 0x800000
    s_lshl_b32 s38, s25, 3
    s_add_u32 s38, s38, s31
    s_sub_i32 s38, 16, s38
    s_max_i32 s38, s38, 0
    s_lshl_b32 s39, s25, 8
    s_lshl_b32 s33, s26, 2
    s_add_u32 s39, s39, s33
    s_add_u32 s39, s39, 0xc10000
    s_lshr_b32 s30, s24, 2
    s_lshl_b32 s96, s56, 8
    s_lshl_b32 s33, s30, 5
    s_add_u32 s96, s96, s33
    s_add_u32 s96, s96, 0xc10000
    v_and_b32 v11, 7, v0
    v_lshlrev_b32 v11, 2, v11
    s_and_b32 s33, s24, 3
    s_lshl_b32 s33, s33, 1
    s_lshl_b32 s32, s56, 3
    s_add_u32 s32, s32, s33
    s_lshl_b32 s97, s32, 15
    s_lshl_b32 s33, s30, 14
    s_add_u32 s97, s97, s33
    s_add_u32 s97, s97, 0x800000
    s_lshl_b32 s33, s30, 15
    s_add_u32 s98, s97, 32768
    s_sub_u32 s98, s98, s33
    s_add_u32 s97, s97, s33
    s_add_u32 s32, s32, s30
    s_mov_b32 s99, 0
    s_mov_b32 s10, 0
    s_mov_b32 s58, 0
    s_cmp_eq_u32 s38, 0
    s_cbranch_scc1 L_MLOKq
    v_mov_b32 v24, v5
    v_mov_b32 v25, v5
    v_mov_b32 v26, v5
    v_mov_b32 v27, v5
L_MLOKq:
    s_mov_b32 s34, 0x33800000
    s_mov_b32 s35, 0x53800000
    v_mov_b32 v54, s34
    v_mov_b32 v55, s35
    s_branch L_ATT
L_KV:
    s_lshr_b32 s30, s24, 1
    s_and_b32 s31, s24, 1
    s_waitcnt lgkmcnt(0)
    s_mov_b32 s20, s42
    s_mov_b32 s21, s43
    s_mov_b32 s22, 0x4000000
    s_mov_b32 s23, 0x00020000
    s_mov_b32 s44, s8
    s_mov_b32 s45, s9
    s_mov_b32 s46, 0x200000
    s_mov_b32 s47, 0x00020000
    s_mov_b32 s48, s10
    s_mov_b32 s49, s11
    s_mov_b32 s50, 0x400000
    s_mov_b32 s51, 0x00020000
    s_mov_b32 s52, s40
    s_mov_b32 s53, s41
    s_mov_b32 s54, 0x100
    s_mov_b32 s55, 0x00020000
    s_or_b32 s32, s24, s26
    s_cmp_lg_u32 s32, 0
    s_cbranch_scc1 L_NOINIT
    v_mov_b32 v12, 0
    v_mov_b32 v13, 0
    v_mov_b32 v14, 0
    v_mov_b32 v15, 0
    v_and_b32 v16, 15, v0
    v_lshlrev_b32 v17, 7, v16
    v_lshlrev_b32 v16, 4, v16
    s_lshl_b32 s32, s25, 11
    s_add_u32 s32, s32, 0xc00000
    s_lshl_b32 s33, s25, 8
    s_add_u32 s33, s33, 0xc10000
    s_mov_b64 exec, 0xffff
    buffer_store_dwordx4 v[12:15], v17, s[20:23], s32 offen sc1
    buffer_store_dwordx4 v[12:15], v16, s[20:23], s33 offen sc1
    s_mov_b64 exec, 1
    v_mov_b32 v18, 1
    s_waitcnt vmcnt(0)
    buffer_store_byte v18, v12, s[52:55], s25 offen sc1
    s_mov_b64 exec, -1
L_NOINIT:
    v_and_b32 v12, 15, v0
    v_lshrrev_b32 v13, 4, v0
    v_lshrrev_b32 v14, 1, v12
    v_xor_b32 v14, v14, v13
    s_lshl_b32 s32, s30, 13
    v_lshlrev_b32 v15, 7, v12
    v_add_u32 v15, s32, v15
    v_add_u32 v15, 0x10000, v15
    v_xor_b32 v16, 0, v14
    v_lshlrev_b32 v16, 4, v16
    v_add_u32 v4, v15, v16
    v_xor_b32 v16, 4, v14
    v_lshlrev_b32 v16, 4, v16
    v_add_u32 v5, v15, v16
    v_lshrrev_b32 v17, 2, v12
    v_and_b32 v18, 3, v12
    v_lshlrev_b32 v20, 3, v13
    v_add_u32 v20, v20, v17
    v_lshlrev_b32 v20, 7, v20
    v_lshrrev_b32 v21, 1, v17
    v_and_b32 v22, 1, v13
    v_lshlrev_b32 v22, 1, v22
    v_or_b32 v21, v21, v22
    s_lshl_b32 s33, s31, 1
    v_xor_b32 v21, s33, v21
    v_lshlrev_b32 v21, 5, v21
    v_lshlrev_b32 v22, 3, v18
    v_add3_u32 v6, v21, v22, v20
    v_xor_b32 v7, 32, v6
    v_mov_b32 v8, v4
    v_mov_b32 v10, v6
    v_mov_b32 v9, v5
    v_mov_b32 v11, v7
    v_mov_b32 v64, 0
    v_mov_b32 v65, 0
    v_mov_b32 v66, 0
    v_mov_b32 v67, 0
    v_mov_b32 v68, 0
    v_mov_b32 v69, 0
    v_mov_b32 v70, 0
    v_mov_b32 v71, 0
    v_mov_b32 v72, 0
    v_mov_b32 v73, 0
    v_mov_b32 v74, 0
    v_mov_b32 v75, 0
    v_mov_b32 v76, 0
    v_mov_b32 v77, 0
    v_mov_b32 v78, 0
    v_mov_b32 v79, 0
    v_mov_b32 v80, 0
    v_mov_b32 v81, 0
    v_mov_b32 v82, 0
    v_mov_b32 v83, 0
    v_mov_b32 v84, 0
    v_mov_b32 v85, 0
    v_mov_b32 v86, 0
    v_mov_b32 v87, 0
    v_mov_b32 v88, 0
    v_mov_b32 v89, 0
    v_mov_b32 v90, 0
    v_mov_b32 v91, 0
    v_mov_b32 v92, 0
    v_mov_b32 v93, 0
    v_mov_b32 v94, 0
    v_mov_b32 v95, 0
    v_mov_b32 v96, 0
    v_mov_b32 v97, 0
    v_mov_b32 v98, 0
    v_mov_b32 v99, 0
    v_mov_b32 v100, 0
    v_mov_b32 v101, 0
    v_mov_b32 v102, 0
    v_mov_b32 v103, 0
    v_mov_b32 v104, 0
    v_mov_b32 v105, 0
    v_mov_b32 v106, 0
    v_mov_b32 v107, 0
    v_mov_b32 v108, 0
    v_mov_b32 v109, 0
    v_mov_b32 v110, 0
    v_mov_b32 v111, 0
    v_mov_b32 v112, 0
    v_mov_b32 v113, 0
    v_mov_b32 v114, 0
    v_mov_b32 v115, 0
    v_mov_b32 v116, 0
    v_mov_b32 v117, 0
    v_mov_b32 v118, 0
    v_mov_b32 v119, 0
    v_mov_b32 v120, 0
    v_mov_b32 v121, 0
    v_mov_b32 v122, 0
    v_mov_b32 v123, 0
    v_mov_b32 v124, 0
    v_mov_b32 v125, 0
    v_mov_b32 v126, 0
    v_mov_b32 v127, 0
    s_mov_b32 s34, 16384
    s_mov_b32 s35, 0
    s_barrier
    ds_read_b128 v[128:131], v8 offset:0
    ds_read_b64_tr_b16 v[144:145], v10 offset:0
    ds_read_b64_tr_b16 v[146:147], v10 offset:512
    ds_read_b128 v[132:135], v8 offset:2048
    ds_read_b128 v[136:139], v8 offset:4096
    ds_read_b128 v[140:143], v8 offset:6144
    ds_read_b64_tr_b16 v[148:149], v11 offset:0
    ds_read_b64_tr_b16 v[150:151], v11 offset:512
    ds_read_b64_tr_b16 v[152:153], v10 offset:8192
    ds_read_b64_tr_b16 v[154:155], v10 offset:8704
    ds_read_b64_tr_b16 v[156:157], v11 offset:8192
    ds_read_b64_tr_b16 v[158:159], v11 offset:8704
L_G1LOOP:
    s_waitcnt lgkmcnt(9)
    v_mfma_f32_16x16x32_bf16 v[64:67], v[144:147], v[128:131], v[64:67]
    ds_read_b128 v[160:163], v9 offset:0
    s_waitcnt lgkmcnt(9)
    v_mfma_f32_16x16x32_bf16 v[80:83], v[144:147], v[132:135], v[80:83]
    ds_read_b64_tr_b16 v[176:177], v10 offset:4096
    s_waitcnt lgkmcnt(9)
    v_mfma_f32_16x16x32_bf16 v[96:99], v[144:147], v[136:139], v[96:99]
    ds_read_b64_tr_b16 v[178:179], v10 offset:4608
    s_waitcnt lgkmcnt(9)
    v_mfma_f32_16x16x32_bf16 v[112:115], v[144:147], v[140:143], v[112:115]
    ds_read_b128 v[164:167], v9 offset:2048
    s_waitcnt lgkmcnt(8)
    v_mfma_f32_16x16x32_bf16 v[68:71], v[148:151], v[128:131], v[68:71]
    ds_read_b128 v[168:171], v9 offset:4096
    v_mfma_f32_16x16x32_bf16 v[84:87], v[148:151], v[132:135], v[84:87]
    ds_read_b128 v[172:175], v9 offset:6144
    v_mfma_f32_16x16x32_bf16 v[100:103], v[148:151], v[136:139], v[100:103]
    ds_read_b64_tr_b16 v[180:181], v11 offset:4096
    v_mfma_f32_16x16x32_bf16 v[116:119], v[148:151], v[140:143], v[116:119]
    ds_read_b64_tr_b16 v[182:183], v11 offset:4608
    s_waitcnt lgkmcnt(10)
    v_mfma_f32_16x16x32_bf16 v[72:75], v[128:131], v[152:155], v[72:75]
    ds_read_b64_tr_b16 v[184:185], v10 offset:12288
    v_mfma_f32_16x16x32_bf16 v[88:91], v[132:135], v[152:155], v[88:91]
    ds_read_b64_tr_b16 v[186:187], v10 offset:12800
    v_mfma_f32_16x16x32_bf16 v[104:107], v[136:139], v[152:155], v[104:107]
    ds_read_b64_tr_b16 v[188:189], v11 offset:12288
    v_mfma_f32_16x16x32_bf16 v[120:123], v[140:143], v[152:155], v[120:123]
    ds_read_b64_tr_b16 v[190:191], v11 offset:12800
    s_waitcnt lgkmcnt(12)
    v_mfma_f32_16x16x32_bf16 v[76:79], v[128:131], v[156:159], v[76:79]
    v_mfma_f32_16x16x32_bf16 v[92:95], v[132:135], v[156:159], v[92:95]
    s_add_u32 s35, s35, 1
    v_mfma_f32_16x16x32_bf16 v[108:111], v[136:139], v[156:159], v[108:111]
    v_mfma_f32_16x16x32_bf16 v[124:127], v[140:143], v[156:159], v[124:127]
    s_waitcnt lgkmcnt(9)
    v_mfma_f32_16x16x32_bf16 v[64:67], v[176:179], v[160:163], v[64:67]
    v_add_u32 v8, s34, v4
    v_add_u32 v10, s34, v6
    s_waitcnt lgkmcnt(8)
    v_mfma_f32_16x16x32_bf16 v[80:83], v[176:179], v[164:167], v[80:83]
    v_add_u32 v9, s34, v5
    v_add_u32 v11, s34, v7
    s_waitcnt lgkmcnt(7)
    v_mfma_f32_16x16x32_bf16 v[96:99], v[176:179], v[168:171], v[96:99]
    s_waitcnt lgkmcnt(0)
    s_barrier
    v_mfma_f32_16x16x32_bf16 v[112:115], v[176:179], v[172:175], v[112:115]
    ds_read_b128 v[128:131], v8 offset:0
    v_mfma_f32_16x16x32_bf16 v[68:71], v[180:183], v[160:163], v[68:71]
    ds_read_b64_tr_b16 v[144:145], v10 offset:0
    v_mfma_f32_16x16x32_bf16 v[84:87], v[180:183], v[164:167], v[84:87]
    ds_read_b64_tr_b16 v[146:147], v10 offset:512
    v_mfma_f32_16x16x32_bf16 v[100:103], v[180:183], v[168:171], v[100:103]
    ds_read_b128 v[132:135], v8 offset:2048
    v_mfma_f32_16x16x32_bf16 v[116:119], v[180:183], v[172:175], v[116:119]
    ds_read_b128 v[136:139], v8 offset:4096
    v_mfma_f32_16x16x32_bf16 v[72:75], v[160:163], v[184:187], v[72:75]
    ds_read_b128 v[140:143], v8 offset:6144
    v_mfma_f32_16x16x32_bf16 v[88:91], v[164:167], v[184:187], v[88:91]
    ds_read_b64_tr_b16 v[148:149], v11 offset:0
    v_mfma_f32_16x16x32_bf16 v[104:107], v[168:171], v[184:187], v[104:107]
    ds_read_b64_tr_b16 v[150:151], v11 offset:512
    v_mfma_f32_16x16x32_bf16 v[120:123], v[172:175], v[184:187], v[120:123]
    ds_read_b64_tr_b16 v[152:153], v10 offset:8192
    v_mfma_f32_16x16x32_bf16 v[76:79], v[160:163], v[188:191], v[76:79]
    ds_read_b64_tr_b16 v[154:155], v10 offset:8704
    v_mfma_f32_16x16x32_bf16 v[92:95], v[164:167], v[188:191], v[92:95]
    ds_read_b64_tr_b16 v[156:157], v11 offset:8192
    v_mfma_f32_16x16x32_bf16 v[108:111], v[168:171], v[188:191], v[108:111]
    ds_read_b64_tr_b16 v[158:159], v11 offset:8704
    s_add_u32 s34, s34, 16384
    s_and_b32 s34, s34, 0xffff
    s_cmp_lt_u32 s35, 12
    v_mfma_f32_16x16x32_bf16 v[124:127], v[172:175], v[188:191], v[124:127]
    s_cbranch_scc1 L_G1LOOP
    s_lshl_b32 s36, s26, 1
    s_add_u32 s36, s36, s31
    s_lshl_b32 s36, s36, 7
    s_lshl_b32 s37, s25, 3
    s_lshl_b32 s38, s30, 2
    s_add_u32 s37, s37, s38
    s_add_u32 s36, s36, s37
    s_lshl_b32 s36, s36, 10
    s_add_u32 s37, s36, 0x400000
    s_waitcnt lgkmcnt(9)
    v_mfma_f32_16x16x32_bf16 v[64:67], v[144:147], v[128:131], v[64:67]
    ds_read_b128 v[160:163], v5 offset:0
    s_waitcnt lgkmcnt(9)
    v_mfma_f32_16x16x32_bf16 v[80:83], v[144:147], v[132:135], v[80:83]
    ds_read_b64_tr_b16 v[176:177], v6 offset:4096
    s_waitcnt lgkmcnt(9)
    v_mfma_f32_16x16x32_bf16 v[96:99], v[144:147], v[136:139], v[96:99]
    ds_read_b64_tr_b16 v[178:179], v6 offset:4608
    s_waitcnt lgkmcnt(9)
    v_mfma_f32_16x16x32_bf16 v[112:115], v[144:147], v[140:143], v[112:115]
    ds_read_b128 v[164:167], v5 offset:2048
    s_waitcnt lgkmcnt(8)
    v_mfma_f32_16x16x32_bf16 v[68:71], v[148:151], v[128:131], v[68:71]
    ds_read_b128 v[168:171], v5 offset:4096
    v_mfma_f32_16x16x32_bf16 v[84:87], v[148:151], v[132:135], v[84:87]
    ds_read_b128 v[172:175], v5 offset:6144
    v_mfma_f32_16x16x32_bf16 v[100:103], v[148:151], v[136:139], v[100:103]
    ds_read_b64_tr_b16 v[180:181], v7 offset:4096
    v_mfma_f32_16x16x32_bf16 v[116:119], v[148:151], v[140:143], v[116:119]
    ds_read_b64_tr_b16 v[182:183], v7 offset:4608
    s_waitcnt lgkmcnt(10)
    v_mfma_f32_16x16x32_bf16 v[72:75], v[128:131], v[152:155], v[72:75]
    v_mfma_f32_16x16x32_bf16 v[88:91], v[132:135], v[152:155], v[88:91]
    v_mfma_f32_16x16x32_bf16 v[104:107], v[136:139], v[152:155], v[104:107]
    v_mfma_f32_16x16x32_bf16 v[120:123], v[140:143], v[152:155], v[120:123]
    s_waitcnt lgkmcnt(8)
    v_mfma_f32_16x16x32_bf16 v[76:79], v[128:131], v[156:159], v[76:79]
    v_mfma_f32_16x16x32_bf16 v[92:95], v[132:135], v[156:159], v[92:95]
    v_mfma_f32_16x16x32_bf16 v[108:111], v[136:139], v[156:159], v[108:111]
    v_mfma_f32_16x16x32_bf16 v[124:127], v[140:143], v[156:159], v[124:127]
    s_waitcnt lgkmcnt(5)
    v_mfma_f32_16x16x32_bf16 v[64:67], v[176:179], v[160:163], v[64:67]
    s_waitcnt lgkmcnt(0)
    s_barrier
    ds_read_b128 v[128:131], v4 offset:16384
    ds_read_b64_tr_b16 v[144:145], v6 offset:16384
    v_mfma_f32_16x16x32_bf16 v[80:83], v[176:179], v[164:167], v[80:83]
    ds_read_b64_tr_b16 v[146:147], v6 offset:16896
    v_mfma_f32_16x16x32_bf16 v[96:99], v[176:179], v[168:171], v[96:99]
    ds_read_b128 v[132:135], v4 offset:18432
    v_mfma_f32_16x16x32_bf16 v[112:115], v[176:179], v[172:175], v[112:115]
    ds_read_b128 v[136:139], v4 offset:20480
    v_mfma_f32_16x16x32_bf16 v[68:71], v[180:183], v[160:163], v[68:71]
    ds_read_b128 v[140:143], v4 offset:22528
    v_mfma_f32_16x16x32_bf16 v[84:87], v[180:183], v[164:167], v[84:87]
    ds_read_b64_tr_b16 v[148:149], v7 offset:16384
    v_mfma_f32_16x16x32_bf16 v[100:103], v[180:183], v[168:171], v[100:103]
    ds_read_b64_tr_b16 v[150:151], v7 offset:16896
    v_mfma_f32_16x16x32_bf16 v[116:119], v[180:183], v[172:175], v[116:119]
    s_waitcnt lgkmcnt(5)
    v_mfma_f32_16x16x32_bf16 v[64:67], v[144:147], v[128:131], v[64:67]
    ds_read_b128 v[160:163], v5 offset:16384
    ds_read_b64_tr_b16 v[176:177], v6 offset:20480
    s_waitcnt lgkmcnt(6)
    v_mfma_f32_16x16x32_bf16 v[80:83], v[144:147], v[132:135], v[80:83]
    ds_read_b64_tr_b16 v[178:179], v6 offset:20992
    s_waitcnt lgkmcnt(6)
    v_mfma_f32_16x16x32_bf16 v[96:99], v[144:147], v[136:139], v[96:99]
    ds_read_b128 v[164:167], v5 offset:18432
    s_waitcnt lgkmcnt(6)
    v_mfma_f32_16x16x32_bf16 v[112:115], v[144:147], v[140:143], v[112:115]
    ds_read_b128 v[168:171], v5 offset:20480
    s_waitcnt lgkmcnt(5)
    v_mfma_f32_16x16x32_bf16 v[68:71], v[148:151], v[128:131], v[68:71]
    ds_read_b128 v[172:175], v5 offset:22528
    v_mfma_f32_16x16x32_bf16 v[84:87], v[148:151], v[132:135], v[84:87]
    ds_read_b64_tr_b16 v[180:181], v7 offset:20480
    v_mfma_f32_16x16x32_bf16 v[100:103], v[148:151], v[136:139], v[100:103]
    ds_read_b64_tr_b16 v[182:183], v7 offset:20992
    v_mfma_f32_16x16x32_bf16 v[116:119], v[148:151], v[140:143], v[116:119]
    s_waitcnt lgkmcnt(5)
    v_mfma_f32_16x16x32_bf16 v[64:67], v[176:179], v[160:163], v[64:67]
    s_waitcnt lgkmcnt(0)
    s_barrier
    ds_read_b128 v[128:131], v4 offset:32768
    ds_read_b64_tr_b16 v[144:145], v6 offset:32768
    v_mfma_f32_16x16x32_bf16 v[80:83], v[176:179], v[164:167], v[80:83]
    ds_read_b64_tr_b16 v[146:147], v6 offset:33280
    v_mfma_f32_16x16x32_bf16 v[96:99], v[176:179], v[168:171], v[96:99]
    ds_read_b128 v[132:135], v4 offset:34816
    v_mfma_f32_16x16x32_bf16 v[112:115], v[176:179], v[172:175], v[112:115]
    ds_read_b128 v[136:139], v4 offset:36864
    v_mfma_f32_16x16x32_bf16 v[68:71], v[180:183], v[160:163], v[68:71]
    ds_read_b128 v[140:143], v4 offset:38912
    v_mfma_f32_16x16x32_bf16 v[84:87], v[180:183], v[164:167], v[84:87]
    ds_read_b64_tr_b16 v[148:149], v7 offset:32768
    v_mfma_f32_16x16x32_bf16 v[100:103], v[180:183], v[168:171], v[100:103]
    ds_read_b64_tr_b16 v[150:151], v7 offset:33280
    v_mfma_f32_16x16x32_bf16 v[116:119], v[180:183], v[172:175], v[116:119]
    s_waitcnt lgkmcnt(5)
    v_mfma_f32_16x16x32_bf16 v[64:67], v[144:147], v[128:131], v[64:67]
    ds_read_b128 v[160:163], v5 offset:32768
    ds_read_b64_tr_b16 v[176:177], v6 offset:36864
    s_waitcnt lgkmcnt(6)
    v_mfma_f32_16x16x32_bf16 v[80:83], v[144:147], v[132:135], v[80:83]
    ds_read_b64_tr_b16 v[178:179], v6 offset:37376
    s_waitcnt lgkmcnt(6)
    v_mfma_f32_16x16x32_bf16 v[96:99], v[144:147], v[136:139], v[96:99]
    ds_read_b128 v[164:167], v5 offset:34816
    s_waitcnt lgkmcnt(6)
    v_mfma_f32_16x16x32_bf16 v[112:115], v[144:147], v[140:143], v[112:115]
    ds_read_b128 v[168:171], v5 offset:36864
    s_waitcnt lgkmcnt(5)
    v_mfma_f32_16x16x32_bf16 v[68:71], v[148:151], v[128:131], v[68:71]
    ds_read_b128 v[172:175], v5 offset:38912
    v_mfma_f32_16x16x32_bf16 v[84:87], v[148:151], v[132:135], v[84:87]
    ds_read_b64_tr_b16 v[180:181], v7 offset:36864
    v_mfma_f32_16x16x32_bf16 v[100:103], v[148:151], v[136:139], v[100:103]
    ds_read_b64_tr_b16 v[182:183], v7 offset:37376
    v_mfma_f32_16x16x32_bf16 v[116:119], v[148:151], v[140:143], v[116:119]
    s_waitcnt lgkmcnt(5)
    v_mfma_f32_16x16x32_bf16 v[64:67], v[176:179], v[160:163], v[64:67]
    s_waitcnt lgkmcnt(0)
    s_barrier
    ds_read_b128 v[128:131], v4 offset:49152
    ds_read_b64_tr_b16 v[144:145], v6 offset:49152
    v_mfma_f32_16x16x32_bf16 v[80:83], v[176:179], v[164:167], v[80:83]
    ds_read_b64_tr_b16 v[146:147], v6 offset:49664
    v_mfma_f32_16x16x32_bf16 v[96:99], v[176:179], v[168:171], v[96:99]
    ds_read_b128 v[132:135], v4 offset:51200
    v_mfma_f32_16x16x32_bf16 v[112:115], v[176:179], v[172:175], v[112:115]
    ds_read_b128 v[136:139], v4 offset:53248
    v_mfma_f32_16x16x32_bf16 v[68:71], v[180:183], v[160:163], v[68:71]
    ds_read_b128 v[140:143], v4 offset:55296
    v_mfma_f32_16x16x32_bf16 v[84:87], v[180:183], v[164:167], v[84:87]
    ds_read_b64_tr_b16 v[148:149], v7 offset:49152
    v_mfma_f32_16x16x32_bf16 v[100:103], v[180:183], v[168:171], v[100:103]
    ds_read_b64_tr_b16 v[150:151], v7 offset:49664
    v_mfma_f32_16x16x32_bf16 v[116:119], v[180:183], v[172:175], v[116:119]
    s_waitcnt lgkmcnt(5)
    v_mfma_f32_16x16x32_bf16 v[64:67], v[144:147], v[128:131], v[64:67]
    ds_read_b128 v[160:163], v5 offset:49152
    ds_read_b64_tr_b16 v[176:177], v6 offset:53248
    s_waitcnt lgkmcnt(6)
    v_mfma_f32_16x16x32_bf16 v[80:83], v[144:147], v[132:135], v[80:83]
    ds_read_b64_tr_b16 v[178:179], v6 offset:53760
    s_waitcnt lgkmcnt(6)
    v_mfma_f32_16x16x32_bf16 v[96:99], v[144:147], v[136:139], v[96:99]
    ds_read_b128 v[164:167], v5 offset:51200
    s_waitcnt lgkmcnt(6)
    v_mfma_f32_16x16x32_bf16 v[112:115], v[144:147], v[140:143], v[112:115]
    ds_read_b128 v[168:171], v5 offset:53248
    s_waitcnt lgkmcnt(5)
    v_mfma_f32_16x16x32_bf16 v[68:71], v[148:151], v[128:131], v[68:71]
    ds_read_b128 v[172:175], v5 offset:55296
    v_mfma_f32_16x16x32_bf16 v[84:87], v[148:151], v[132:135], v[84:87]
    ds_read_b64_tr_b16 v[180:181], v7 offset:53248
    v_mfma_f32_16x16x32_bf16 v[100:103], v[148:151], v[136:139], v[100:103]
    ds_read_b64_tr_b16 v[182:183], v7 offset:53760
    v_mfma_f32_16x16x32_bf16 v[116:119], v[148:151], v[140:143], v[116:119]
    s_waitcnt lgkmcnt(5)
    v_mfma_f32_16x16x32_bf16 v[64:67], v[176:179], v[160:163], v[64:67]
    s_waitcnt lgkmcnt(0)
    s_barrier
    ds_read_b128 v[128:131], v5 offset:0
    ds_read_b64_tr_b16 v[152:153], v6 offset:12288
    v_mfma_f32_16x16x32_bf16 v[80:83], v[176:179], v[164:167], v[80:83]
    ds_read_b64_tr_b16 v[154:155], v6 offset:12800
    v_mfma_f32_16x16x32_bf16 v[96:99], v[176:179], v[168:171], v[96:99]
    ds_read_b128 v[132:135], v5 offset:2048
    v_mfma_f32_16x16x32_bf16 v[112:115], v[176:179], v[172:175], v[112:115]
    ds_read_b128 v[136:139], v5 offset:4096
    v_mfma_f32_16x16x32_bf16 v[68:71], v[180:183], v[160:163], v[68:71]
    ds_read_b128 v[140:143], v5 offset:6144
    v_mfma_f32_16x16x32_bf16 v[84:87], v[180:183], v[164:167], v[84:87]
    ds_read_b64_tr_b16 v[156:157], v7 offset:12288
    v_mfma_f32_16x16x32_bf16 v[100:103], v[180:183], v[168:171], v[100:103]
    ds_read_b64_tr_b16 v[158:159], v7 offset:12800
    v_mfma_f32_16x16x32_bf16 v[116:119], v[180:183], v[172:175], v[116:119]
    s_waitcnt lgkmcnt(5)
    v_mfma_f32_16x16x32_bf16 v[72:75], v[128:131], v[152:155], v[72:75]
    ds_read_b128 v[160:163], v4 offset:16384
    ds_read_b64_tr_b16 v[184:185], v6 offset:24576
    s_waitcnt lgkmcnt(6)
    v_mfma_f32_16x16x32_bf16 v[88:91], v[132:135], v[152:155], v[88:91]
    ds_read_b64_tr_b16 v[186:187], v6 offset:25088
    s_waitcnt lgkmcnt(6)
    v_mfma_f32_16x16x32_bf16 v[104:107], v[136:139], v[152:155], v[104:107]
    ds_read_b128 v[164:167], v4 offset:18432
    s_waitcnt lgkmcnt(6)
    v_mfma_f32_16x16x32_bf16 v[120:123], v[140:143], v[152:155], v[120:123]
    ds_read_b128 v[168:171], v4 offset:20480
    s_waitcnt lgkmcnt(5)
    v_mfma_f32_16x16x32_bf16 v[76:79], v[128:131], v[156:159], v[76:79]
    ds_read_b128 v[172:175], v4 offset:22528
    v_mfma_f32_16x16x32_bf16 v[92:95], v[132:135], v[156:159], v[92:95]
    ds_read_b64_tr_b16 v[188:189], v7 offset:24576
    v_mfma_f32_16x16x32_bf16 v[108:111], v[136:139], v[156:159], v[108:111]
    ds_read_b64_tr_b16 v[190:191], v7 offset:25088
    v_mfma_f32_16x16x32_bf16 v[124:127], v[140:143], v[156:159], v[124:127]
    s_waitcnt lgkmcnt(5)
    v_mfma_f32_16x16x32_bf16 v[72:75], v[160:163], v[184:187], v[72:75]
    ds_read_b128 v[128:131], v5 offset:16384
    ds_read_b64_tr_b16 v[152:153], v6 offset:28672
    s_waitcnt lgkmcnt(6)
    v_mfma_f32_16x16x32_bf16 v[88:91], v[164:167], v[184:187], v[88:91]
    ds_read_b64_tr_b16 v[154:155], v6 offset:29184
    v_cvt_pk_bf16_f32 v192, v64, v65
    v_cvt_pk_bf16_f32 v193, v66, v67
    v_cvt_pk_bf16_f32 v194, v68, v69
    v_cvt_pk_bf16_f32 v195, v70, v71
    buffer_store_dwordx4 v[192:195], v1, s[20:23], s36 offen offset:0 sc1
    s_waitcnt lgkmcnt(6)
    v_mfma_f32_16x16x32_bf16 v[104:107], v[168:171], v[184:187], v[104:107]
    ds_read_b128 v[132:135], v5 offset:18432
    s_waitcnt lgkmcnt(6)
    v_mfma_f32_16x16x32_bf16 v[120:123], v[172:175], v[184:187], v[120:123]
    ds_read_b128 v[136:139], v5 offset:20480
    s_waitcnt lgkmcnt(5)
    v_mfma_f32_16x16x32_bf16 v[76:79], v[160:163], v[188:191], v[76:79]
    ds_read_b128 v[140:143], v5 offset:22528
    v_mfma_f32_16x16x32_bf16 v[92:95], v[164:167], v[188:191], v[92:95]
    ds_read_b64_tr_b16 v[156:157], v7 offset:28672
    v_cvt_pk_bf16_f32 v200, v80, v81
    v_cvt_pk_bf16_f32 v201, v82, v83
    v_cvt_pk_bf16_f32 v202, v84, v85
    v_cvt_pk_bf16_f32 v203, v86, v87
    buffer_store_dwordx4 v[200:203], v1, s[20:23], s36 offen offset:1024 sc1
    v_mfma_f32_16x16x32_bf16 v[108:111], v[168:171], v[188:191], v[108:111]
    ds_read_b64_tr_b16 v[158:159], v7 offset:29184
    v_mfma_f32_16x16x32_bf16 v[124:127], v[172:175], v[188:191], v[124:127]
    s_waitcnt lgkmcnt(5)
    v_mfma_f32_16x16x32_bf16 v[72:75], v[128:131], v[152:155], v[72:75]
    ds_read_b128 v[160:163], v4 offset:32768
    ds_read_b64_tr_b16 v[184:185], v6 offset:40960
    s_waitcnt lgkmcnt(6)
    v_mfma_f32_16x16x32_bf16 v[88:91], v[132:135], v[152:155], v[88:91]
    ds_read_b64_tr_b16 v[186:187], v6 offset:41472
    v_cvt_pk_bf16_f32 v208, v96, v97
    v_cvt_pk_bf16_f32 v209, v98, v99
    v_cvt_pk_bf16_f32 v210, v100, v101
    v_cvt_pk_bf16_f32 v211, v102, v103
    buffer_store_dwordx4 v[208:211], v1, s[20:23], s36 offen offset:2048 sc1
    s_waitcnt lgkmcnt(6)
    v_mfma_f32_16x16x32_bf16 v[104:107], v[136:139], v[152:155], v[104:107]
    ds_read_b128 v[164:167], v4 offset:34816
    s_waitcnt lgkmcnt(6)
    v_mfma_f32_16x16x32_bf16 v[120:123], v[140:143], v[152:155], v[120:123]
    ds_read_b128 v[168:171], v4 offset:36864
    s_waitcnt lgkmcnt(5)
    v_mfma_f32_16x16x32_bf16 v[76:79], v[128:131], v[156:159], v[76:79]
    ds_read_b128 v[172:175], v4 offset:38912
    v_mfma_f32_16x16x32_bf16 v[92:95], v[132:135], v[156:159], v[92:95]
    ds_read_b64_tr_b16 v[188:189], v7 offset:40960
    v_cvt_pk_bf16_f32 v216, v112, v113
    v_cvt_pk_bf16_f32 v217, v114, v115
    v_cvt_pk_bf16_f32 v218, v116, v117
    v_cvt_pk_bf16_f32 v219, v118, v119
    buffer_store_dwordx4 v[216:219], v1, s[20:23], s36 offen offset:3072 sc1
    v_mfma_f32_16x16x32_bf16 v[108:111], v[136:139], v[156:159], v[108:111]
    ds_read_b64_tr_b16 v[190:191], v7 offset:41472
    v_mfma_f32_16x16x32_bf16 v[124:127], v[140:143], v[156:159], v[124:127]
    s_waitcnt lgkmcnt(5)
    v_mfma_f32_16x16x32_bf16 v[72:75], v[160:163], v[184:187], v[72:75]
    ds_read_b128 v[128:131], v5 offset:32768
    ds_read_b64_tr_b16 v[152:153], v6 offset:45056
    s_waitcnt lgkmcnt(6)
    v_mfma_f32_16x16x32_bf16 v[88:91], v[164:167], v[184:187], v[88:91]
    ds_read_b64_tr_b16 v[154:155], v6 offset:45568
    s_waitcnt lgkmcnt(6)
    v_mfma_f32_16x16x32_bf16 v[104:107], v[168:171], v[184:187], v[104:107]
    ds_read_b128 v[132:135], v5 offset:34816
    s_waitcnt lgkmcnt(6)
    v_mfma_f32_16x16x32_bf16 v[120:123], v[172:175], v[184:187], v[120:123]
    ds_read_b128 v[136:139], v5 offset:36864
    s_waitcnt lgkmcnt(5)
    v_mfma_f32_16x16x32_bf16 v[76:79], v[160:163], v[188:191], v[76:79]
    ds_read_b128 v[140:143], v5 offset:38912
    v_mfma_f32_16x16x32_bf16 v[92:95], v[164:167], v[188:191], v[92:95]
    ds_read_b64_tr_b16 v[156:157], v7 offset:45056
    v_mfma_f32_16x16x32_bf16 v[108:111], v[168:171], v[188:191], v[108:111]
    ds_read_b64_tr_b16 v[158:159], v7 offset:45568
    v_mfma_f32_16x16x32_bf16 v[124:127], v[172:175], v[188:191], v[124:127]
    s_waitcnt lgkmcnt(5)
    v_mfma_f32_16x16x32_bf16 v[72:75], v[128:131], v[152:155], v[72:75]
    ds_read_b128 v[160:163], v4 offset:49152
    ds_read_b64_tr_b16 v[184:185], v6 offset:57344
    s_waitcnt lgkmcnt(6)
    v_mfma_f32_16x16x32_bf16 v[88:91], v[132:135], v[152:155], v[88:91]
    ds_read_b64_tr_b16 v[186:187], v6 offset:57856
    s_waitcnt lgkmcnt(6)
    v_mfma_f32_16x16x32_bf16 v[104:107], v[136:139], v[152:155], v[104:107]
    ds_read_b128 v[164:167], v4 offset:51200
    s_waitcnt lgkmcnt(6)
    v_mfma_f32_16x16x32_bf16 v[120:123], v[140:143], v[152:155], v[120:123]
    ds_read_b128 v[168:171], v4 offset:53248
    s_waitcnt lgkmcnt(5)
    v_mfma_f32_16x16x32_bf16 v[76:79], v[128:131], v[156:159], v[76:79]
    ds_read_b128 v[172:175], v4 offset:55296
    v_mfma_f32_16x16x32_bf16 v[92:95], v[132:135], v[156:159], v[92:95]
    ds_read_b64_tr_b16 v[188:189], v7 offset:57344
    v_mfma_f32_16x16x32_bf16 v[108:111], v[136:139], v[156:159], v[108:111]
    ds_read_b64_tr_b16 v[190:191], v7 offset:57856
    v_mfma_f32_16x16x32_bf16 v[124:127], v[140:143], v[156:159], v[124:127]
    s_waitcnt lgkmcnt(5)
    v_mfma_f32_16x16x32_bf16 v[72:75], v[160:163], v[184:187], v[72:75]
    ds_read_b128 v[128:131], v5 offset:49152
    ds_read_b64_tr_b16 v[152:153], v6 offset:61440
    s_waitcnt lgkmcnt(6)
    v_mfma_f32_16x16x32_bf16 v[88:91], v[164:167], v[184:187], v[88:91]
    ds_read_b64_tr_b16 v[154:155], v6 offset:61952
    s_waitcnt lgkmcnt(6)
    v_mfma_f32_16x16x32_bf16 v[104:107], v[168:171], v[184:187], v[104:107]
    ds_read_b128 v[132:135], v5 offset:51200
    s_waitcnt lgkmcnt(6)
    v_mfma_f32_16x16x32_bf16 v[120:123], v[172:175], v[184:187], v[120:123]
    ds_read_b128 v[136:139], v5 offset:53248
    s_waitcnt lgkmcnt(5)
    v_mfma_f32_16x16x32_bf16 v[76:79], v[160:163], v[188:191], v[76:79]
    ds_read_b128 v[140:143], v5 offset:55296
    v_mfma_f32_16x16x32_bf16 v[92:95], v[164:167], v[188:191], v[92:95]
    ds_read_b64_tr_b16 v[156:157], v7 offset:61440
    v_mfma_f32_16x16x32_bf16 v[108:111], v[168:171], v[188:191], v[108:111]
    ds_read_b64_tr_b16 v[158:159], v7 offset:61952
    v_mfma_f32_16x16x32_bf16 v[124:127], v[172:175], v[188:191], v[124:127]
    s_waitcnt lgkmcnt(5)
    v_mfma_f32_16x16x32_bf16 v[72:75], v[128:131], v[152:155], v[72:75]
    s_waitcnt lgkmcnt(0)
    s_barrier
    v_mfma_f32_16x16x32_bf16 v[88:91], v[132:135], v[152:155], v[88:91]
    v_mfma_f32_16x16x32_bf16 v[104:107], v[136:139], v[152:155], v[104:107]
    v_mfma_f32_16x16x32_bf16 v[120:123], v[140:143], v[152:155], v[120:123]
    v_mfma_f32_16x16x32_bf16 v[76:79], v[128:131], v[156:159], v[76:79]
    v_mfma_f32_16x16x32_bf16 v[92:95], v[132:135], v[156:159], v[92:95]
    v_mfma_f32_16x16x32_bf16 v[108:111], v[136:139], v[156:159], v[108:111]
    v_mfma_f32_16x16x32_bf16 v[124:127], v[140:143], v[156:159], v[124:127]
    s_lshl_b32 s32, s25, 4
    s_add_u32 s32, s32, s26
    s_lshl_b32 s32, s32, 7
    s_add_u32 s32, s32, 0xc00000
    s_lshl_b32 s33, s24, 2
    s_add_u32 s32, s32, s33
    v_and_b32 v17, 1, v0
    v_add_u32 v17, 1, v17
    v_cmp_ge_u32 s[60:61], s25, v17
    v_lshlrev_b32 v17, 11, v17
    s_nop 0
    v_cndmask_b32_e64 v17, 0, v17, s[60:61]
    v_sub_u32 v17, s32, v17
    buffer_load_dword v20, v17, s[20:23], 0 offen sc1
    v_cvt_pk_bf16_f32 v196, v72, v73
    v_cvt_pk_bf16_f32 v197, v74, v75
    v_cvt_pk_bf16_f32 v198, v76, v77
    v_cvt_pk_bf16_f32 v199, v78, v79
    buffer_store_dwordx4 v[196:199], v1, s[20:23], s37 offen offset:0 sc1
    v_cvt_pk_bf16_f32 v204, v88, v89
    v_cvt_pk_bf16_f32 v205, v90, v91
    v_cvt_pk_bf16_f32 v206, v92, v93
    v_cvt_pk_bf16_f32 v207, v94, v95
    buffer_store_dwordx4 v[204:207], v1, s[20:23], s37 offen offset:1024 sc1
    v_cvt_pk_bf16_f32 v212, v104, v105
    v_cvt_pk_bf16_f32 v213, v106, v107
    v_cvt_pk_bf16_f32 v214, v108, v109
    v_cvt_pk_bf16_f32 v215, v110, v111
    buffer_store_dwordx4 v[212:215], v1, s[20:23], s37 offen offset:2048 sc1
    v_cvt_pk_bf16_f32 v220, v120, v121
    v_cvt_pk_bf16_f32 v221, v122, v123
    v_cvt_pk_bf16_f32 v222, v124, v125
    v_cvt_pk_bf16_f32 v223, v126, v127
    buffer_store_dwordx4 v[220:223], v1, s[20:23], s37 offen offset:3072 sc1
    s_mul_i32 s38, s31, 49152
    s_add_u32 s38, s38, 65536
    s_lshl_b32 s39, s30, 12
    s_add_u32 s38, s38, s39
    v_add_u32 v12, s38, v1
    v_lshlrev_b32 v13, 3, v0
    v_add_u32 v13, s38, v13
    v_mov_b32 v15, 1
    v_mov_b32 v16, 0
    s_barrier
    ds_write_b128 v12, v[192:195] offset:16384
    ds_write_b64 v13, v[196:197] offset:40960
    ds_write_b64 v13, v[198:199] offset:41472
    ds_write_b128 v12, v[200:203] offset:17408
    ds_write_b64 v13, v[204:205] offset:41984
    ds_write_b64 v13, v[206:207] offset:42496
    ds_write_b128 v12, v[208:211] offset:18432
    ds_write_b64 v13, v[212:213] offset:43008
    ds_write_b64 v13, v[214:215] offset:43520
    ds_write_b128 v12, v[216:219] offset:19456
    ds_write_b64 v13, v[220:221] offset:44032
    ds_write_b64 v13, v[222:223] offset:44544
    s_waitcnt vmcnt(0)
    s_mov_b64 exec, 1
    buffer_store_dword v15, v16, s[20:23], s32 offen sc1
    s_mov_b64 exec, -1
    v_cmp_ne_u32 vcc, 1, v20
    s_and_b64 s[58:59], vcc, s[60:61]
    s_cmp_eq_u64 s[58:59], 0
    s_cbranch_scc1 L_HOK
    s_mov_b32 s35, 200000
L_HPOLL:
    buffer_load_dword v20, v17, s[20:23], 0 offen sc1
    s_waitcnt vmcnt(0)
    v_cmp_ne_u32 vcc, 1, v20
    s_and_b64 s[58:59], vcc, s[60:61]
    s_cmp_eq_u64 s[58:59], 0
    s_cbranch_scc1 L_HOK
    s_sub_u32 s35, s35, 1
    s_cmp_lg_u32 s35, 0
    s_cbranch_scc1 L_HPOLL
L_HOK:
    s_cmp_lt_u32 s25, 1
    s_cbranch_scc1 L_HSKIPa1
    s_sub_u32 s38, s36, 8192
    s_sub_u32 s39, s37, 8192
    buffer_load_dwordx4 v[64:67], v1, s[20:23], s38 offen offset:0 sc1
    buffer_load_dwordx4 v[68:71], v1, s[20:23], s39 offen offset:0 sc1
    buffer_load_dwordx4 v[72:75], v1, s[20:23], s38 offen offset:1024 sc1
    buffer_load_dwordx4 v[76:79], v1, s[20:23], s39 offen offset:1024 sc1
    buffer_load_dwordx4 v[80:83], v1, s[20:23], s38 offen offset:2048 sc1
    buffer_load_dwordx4 v[84:87], v1, s[20:23], s39 offen offset:2048 sc1
    buffer_load_dwordx4 v[88:91], v1, s[20:23], s38 offen offset:3072 sc1
    buffer_load_dwordx4 v[92:95], v1, s[20:23], s39 offen offset:3072 sc1
L_HSKIPa1:
    s_cmp_lt_u32 s25, 2
    s_cbranch_scc1 L_HSKIPa2
    s_sub_u32 s38, s36, 16384
    s_sub_u32 s39, s37, 16384
    buffer_load_dwordx4 v[96:99], v1, s[20:23], s38 offen offset:0 sc1
    buffer_load_dwordx4 v[100:103], v1, s[20:23], s39 offen offset:0 sc1
    buffer_load_dwordx4 v[104:107], v1, s[20:23], s38 offen offset:1024 sc1
    buffer_load_dwordx4 v[108:111], v1, s[20:23], s39 offen offset:1024 sc1
    buffer_load_dwordx4 v[112:115], v1, s[20:23], s38 offen offset:2048 sc1
    buffer_load_dwordx4 v[116:119], v1, s[20:23], s39 offen offset:2048 sc1
    buffer_load_dwordx4 v[120:123], v1, s[20:23], s38 offen offset:3072 sc1
    buffer_load_dwordx4 v[124:127], v1, s[20:23], s39 offen offset:3072 sc1
L_HSKIPa2:
    s_and_b32 s56, s27, 3
    s_lshl_b32 s56, s56, 2
    s_and_b32 s29, s28, 3
    s_add_u32 s56, s56, s29
    s_lshr_b32 s57, s27, 2
    s_lshl_b32 s57, s57, 3
    s_lshr_b32 s29, s28, 2
    s_add_u32 s57, s57, s29
    v_lshrrev_b32 v4, 3, v0
    v_and_b32 v5, 7, v0
    v_lshrrev_b32 v6, 4, v0
    v_lshlrev_b32 v6, 1, v6
    v_xor_b32 v6, v6, v5
    v_lshlrev_b32 v6, 4, v6
    v_lshlrev_b32 v10, 11, v4
    v_add_u32 v10, v10, v6
    s_lshl_b32 s30, s57, 7
    v_add_u32 v10, s30, v10
    s_lshl_b32 s61, s24, 10
    s_and_b32 s60, s24, 3
    s_lshl_b32 s60, s60, 14
    s_and_b32 s101, s57, 7
    s_lshr_b32 s100, s24, 2
    s_add_u32 s100, s100, s101
    s_waitcnt lgkmcnt(0)
    v_and_b32 v2, 15, v0
    v_lshrrev_b32 v3, 4, v0
    v_lshlrev_b32 v3, 2, v3
    v_sub_u32 v4, v2, v3
    v_mov_b32 v5, 0xf149f2ca
    v_cmp_le_i32 vcc, 0, v4
    s_nop 1
    v_cndmask_b32_e64 v28, v5, 0, vcc
    v_cndmask_b32_e64 v24, 0, v5, vcc
    v_cmp_le_i32 vcc, 1, v4
    s_nop 1
    v_cndmask_b32_e64 v29, v5, 0, vcc
    v_cndmask_b32_e64 v25, 0, v5, vcc
    v_cmp_le_i32 vcc, 2, v4
    s_nop 1
    v_cndmask_b32_e64 v30, v5, 0, vcc
    v_cndmask_b32_e64 v26, 0, v5, vcc
    v_cmp_le_i32 vcc, 3, v4
    s_nop 1
    v_cndmask_b32_e64 v31, v5, 0, vcc
    v_cndmask_b32_e64 v27, 0, v5, vcc
    v_mov_b32 v32, 0x3f803f80
    v_mov_b32 v33, 0x3f803f80
    v_mov_b32 v34, 0x3f803f80
    v_mov_b32 v35, 0x3f803f80
    s_and_b32 s31, s24, 3
    s_lshl_b32 s31, s31, 1
    s_lshr_b32 s32, s24, 2
    s_add_u32 s31, s31, s32
    s_lshl_b32 s36, s31, 10
    v_add_u32 v6, s36, v1
    v_lshlrev_b32 v7, 3, v0
    v_add_u32 v7, s36, v7
    v_add_u32 v6, 0x10000, v6
    v_add_u32 v7, 0x16000, v7
    v_add_u32 v8, s61, v1
    s_lshl_b32 s37, s25, 3
    s_add_u32 s37, s37, s31
    s_lshl_b32 s37, s37, 5
    s_lshl_b32 s38, s26, 1
    s_add_u32 s37, s37, s38
    s_lshl_b32 s37, s37, 10
    s_add_u32 s37, s37, 0x800000
    s_lshl_b32 s38, s25, 3
    s_add_u32 s38, s38, s31
    s_sub_i32 s38, 16, s38
    s_max_i32 s38, s38, 0
    s_lshl_b32 s39, s25, 8
    s_lshl_b32 s33, s26, 2
    s_add_u32 s39, s39, s33
    s_add_u32 s39, s39, 0xc10000
    s_lshr_b32 s30, s24, 2
    s_lshl_b32 s96, s56, 8
    s_lshl_b32 s33, s30, 5
    s_add_u32 s96, s96, s33
    s_add_u32 s96, s96, 0xc10000
    v_and_b32 v11, 7, v0
    v_lshlrev_b32 v11, 2, v11
    s_and_b32 s33, s24, 3
    s_lshl_b32 s33, s33, 1
    s_lshl_b32 s32, s56, 3
    s_add_u32 s32, s32, s33
    s_lshl_b32 s97, s32, 15
    s_lshl_b32 s33, s30, 14
    s_add_u32 s97, s97, s33
    s_add_u32 s97, s97, 0x800000
    s_lshl_b32 s33, s30, 15
    s_add_u32 s98, s97, 32768
    s_sub_u32 s98, s98, s33
    s_add_u32 s97, s97, s33
    s_add_u32 s32, s32, s30
    s_mov_b32 s99, 0
    s_mov_b32 s10, 0
    s_mov_b32 s58, 0
    s_cmp_eq_u32 s38, 0
    s_cbranch_scc1 L_MLOKk
    v_mov_b32 v24, v5
    v_mov_b32 v25, v5
    v_mov_b32 v26, v5
    v_mov_b32 v27, v5
L_MLOKk:
    s_mov_b32 s34, 0x33800000
    s_mov_b32 s35, 0x53800000
    v_mov_b32 v54, s34
    v_mov_b32 v55, s35
    s_cmp_lt_u32 s25, 2
    s_cbranch_scc1 L_HSMALL
    s_waitcnt vmcnt(14)
    ds_write_b128 v12, v[64:67] offset:8192
    ds_write_b64 v13, v[68:69] offset:32768
    ds_write_b64 v13, v[70:71] offset:33280
    s_waitcnt vmcnt(12)
    ds_write_b128 v12, v[72:75] offset:9216
    ds_write_b64 v13, v[76:77] offset:33792
    ds_write_b64 v13, v[78:79] offset:34304
    s_waitcnt vmcnt(10)
    ds_write_b128 v12, v[80:83] offset:10240
    ds_write_b64 v13, v[84:85] offset:34816
    ds_write_b64 v13, v[86:87] offset:35328
    s_waitcnt vmcnt(8)
    ds_write_b128 v12, v[88:91] offset:11264
    ds_write_b64 v13, v[92:93] offset:35840
    ds_write_b64 v13, v[94:95] offset:36352
    s_waitcnt vmcnt(6)
    ds_write_b128 v12, v[96:99] offset:0
    ds_write_b64 v13, v[100:101] offset:24576
    ds_write_b64 v13, v[102:103] offset:25088
    s_waitcnt vmcnt(4)
    ds_write_b128 v12, v[104:107] offset:1024
    ds_write_b64 v13, v[108:109] offset:25600
    ds_write_b64 v13, v[110:111] offset:26112
    s_waitcnt vmcnt(2)
    ds_write_b128 v12, v[112:115] offset:2048
    ds_write_b64 v13, v[116:117] offset:26624
    ds_write_b64 v13, v[118:119] offset:27136
    s_waitcnt vmcnt(0)
    ds_write_b128 v12, v[120:123] offset:3072
    ds_write_b64 v13, v[124:125] offset:27648
    ds_write_b64 v13, v[126:127] offset:28160
    s_branch L_ATT
L_HSMALL:
    s_cmp_lt_u32 s25, 1
    s_cbranch_scc1 L_ATT
    s_waitcnt vmcnt(0)
    ds_write_b128 v12, v[64:67] offset:8192
    ds_write_b64 v13, v[68:69] offset:32768
    ds_write_b64 v13, v[70:71] offset:33280
    ds_write_b128 v12, v[72:75] offset:9216
    ds_write_b64 v13, v[76:77] offset:33792
    ds_write_b64 v13, v[78:79] offset:34304
    ds_write_b128 v12, v[80:83] offset:10240
    ds_write_b64 v13, v[84:85] offset:34816
    ds_write_b64 v13, v[86:87] offset:35328
    ds_write_b128 v12, v[88:91] offset:11264
    ds_write_b64 v13, v[92:93] offset:35840
    ds_write_b64 v13, v[94:95] offset:36352
L_ATT:
    s_waitcnt lgkmcnt(0)
    s_barrier
    s_cmp_ge_u32 s24, 4
    s_cbranch_scc1 L_NOQRD
    ds_read_b128 v[16:19], v8 offset:0
    ds_read_b128 v[20:23], v8 offset:4096
    v_mov_b32 v2, 0
    v_mov_b32 v3, 0xfc00
    ds_write_b32 v3, v2
    s_waitcnt lgkmcnt(0)
L_NOQRD:
    s_barrier
    s_cmp_lt_u32 s24, 4
    s_cbranch_scc1 L_NOPRIO
    s_setprio 1
L_NOPRIO:
L_ROUND:
    ds_read_b128 v[120:123], v6 offset:0
    ds_read_b128 v[124:127], v6 offset:1024
    ds_read_b128 v[128:131], v6 offset:2048
    ds_read_b128 v[132:135], v6 offset:3072
    ds_read_b128 v[136:139], v6 offset:4096
    ds_read_b128 v[140:143], v6 offset:5120
    s_cmp_gt_u32 s38, 1
    s_cselect_b32 s33, 0xf149f2ca, 0
    v_mov_b32 v48, s33
    v_mov_b32 v49, s33
    v_mov_b32 v50, s33
    v_mov_b32 v51, s33
    ds_read_b64 v[72:73], v7 offset:0
    ds_read_b64 v[74:75], v7 offset:1024
    ds_read_b64 v[76:77], v7 offset:512
    ds_read_b64 v[78:79], v7 offset:1536
    s_waitcnt lgkmcnt(9)
    v_mfma_f32_16x16x32_bf16 v[96:99], v[120:123], v[16:19], v[24:27]
    ds_read_b128 v[120:123], v6 offset:6144
    s_cmp_eq_u32 s38, 1
    s_cbranch_scc1 L_CTR1
L_CT1:
    s_waitcnt lgkmcnt(9)
    v_mfma_f32_16x16x32_bf16 v[100:103], v[124:127], v[16:19], v[48:51]
    ds_read_b128 v[124:127], v6 offset:7168
    s_cmp_eq_u32 s38, 2
    s_cbranch_scc1 L_CTR2
L_CT2:
    s_waitcnt lgkmcnt(9)
    v_mfma_f32_16x16x32_bf16 v[104:107], v[128:131], v[16:19], v[48:51]
    ds_read_b128 v[128:131], v6 offset:8192
    s_cmp_eq_u32 s38, 3
    s_cbranch_scc1 L_CTR3
L_CT3:
    s_waitcnt lgkmcnt(9)
    v_mfma_f32_16x16x32_bf16 v[108:111], v[132:135], v[16:19], v[48:51]
    ds_read_b128 v[132:135], v6 offset:9216
    ds_read_b64 v[80:81], v7 offset:2048
    ds_read_b64 v[82:83], v7 offset:3072
    ds_read_b64 v[84:85], v7 offset:2560
    ds_read_b64 v[86:87], v7 offset:3584
    v_exp_f32 v96, v96
    v_exp_f32 v97, v97
    v_exp_f32 v98, v98
    v_exp_f32 v99, v99
    v_exp_f32 v100, v100
    v_exp_f32 v101, v101
    v_exp_f32 v102, v102
    v_exp_f32 v103, v103
    s_cmp_lg_u32 s58, 0
    s_cbranch_scc1 L_SK0
    s_add_u32 m0, s61, 0
    s_add_u32 s33, s100, 0
    s_and_b32 s33, s33, 7
    s_lshl_b32 s33, s33, 17
    s_add_u32 s33, s33, s60
    buffer_load_dwordx4 v10, s[44:47], s33 offen lds
    s_add_u32 m0, s61, 8192
    s_add_u32 s33, s100, 2
    s_and_b32 s33, s33, 7
    s_lshl_b32 s33, s33, 17
    s_add_u32 s33, s33, s60
    buffer_load_dwordx4 v10, s[44:47], s33 offen lds
L_SK0:
    s_cmp_eq_u32 s38, 4
    s_cbranch_scc1 L_CTR4
L_CT4:
    s_waitcnt lgkmcnt(13)
    v_mfma_f32_16x16x32_bf16 v[112:115], v[136:139], v[16:19], v[48:51]
    ds_read_b128 v[136:139], v6 offset:10240
    v_cvt_pk_bf16_f32 v96, v96, v97
    v_cvt_pk_bf16_f32 v97, v98, v99
    s_cmp_eq_u32 s38, 5
    s_cbranch_scc1 L_CTR5
L_CT5:
    s_waitcnt lgkmcnt(13)
    v_mfma_f32_16x16x32_bf16 v[116:119], v[140:143], v[16:19], v[48:51]
    ds_read_b128 v[140:143], v6 offset:11264
    v_cvt_pk_bf16_f32 v98, v100, v101
    v_cvt_pk_bf16_f32 v99, v102, v103
    v_exp_f32 v104, v104
    v_exp_f32 v105, v105
    s_waitcnt lgkmcnt(12)
    v_mfma_f32_16x16x32_bf16 v[36:39], v[72:75], v[96:99], 0
    v_exp_f32 v106, v106
    v_exp_f32 v107, v107
    s_waitcnt lgkmcnt(10)
    v_mfma_f32_16x16x32_bf16 v[40:43], v[76:79], v[96:99], 0
    v_exp_f32 v108, v108
    v_exp_f32 v109, v109
    v_mfma_f32_16x16x32_bf16 v[44:47], v[32:35], v[96:99], 0
    ds_read_b64 v[88:89], v7 offset:4096
    ds_read_b64 v[90:91], v7 offset:5120
    ds_read_b64 v[92:93], v7 offset:4608
    ds_read_b64 v[94:95], v7 offset:5632
    v_exp_f32 v110, v110
    v_exp_f32 v111, v111
    s_cmp_lg_u32 s58, 0
    s_cbranch_scc1 L_SK1
    s_add_u32 m0, s61, 16384
    s_add_u32 s33, s100, 4
    s_and_b32 s33, s33, 7
    s_lshl_b32 s33, s33, 17
    s_add_u32 s33, s33, s60
    buffer_load_dwordx4 v10, s[44:47], s33 offen lds
    s_add_u32 m0, s61, 24576
    s_add_u32 s33, s100, 6
    s_and_b32 s33, s33, 7
    s_lshl_b32 s33, s33, 17
    s_add_u32 s33, s33, s60
    buffer_load_dwordx4 v10, s[44:47], s33 offen lds
L_SK1:
    s_cmp_eq_u32 s38, 6
    s_cbranch_scc1 L_CTR6
L_CT6:
    s_waitcnt lgkmcnt(13)
    v_mfma_f32_16x16x32_bf16 v[96:99], v[120:123], v[16:19], v[48:51]
    ds_read_b128 v[120:123], v6 offset:12288
    v_cvt_pk_bf16_f32 v104, v104, v105
    v_cvt_pk_bf16_f32 v105, v106, v107
    s_cmp_eq_u32 s38, 7
    s_cbranch_scc1 L_CTR7
L_CT7:
    s_waitcnt lgkmcnt(13)
    v_mfma_f32_16x16x32_bf16 v[100:103], v[124:127], v[16:19], v[48:51]
    ds_read_b128 v[124:127], v6 offset:13312
    v_cvt_pk_bf16_f32 v106, v108, v109
    v_cvt_pk_bf16_f32 v107, v110, v111
    v_exp_f32 v112, v112
    v_exp_f32 v113, v113
    s_waitcnt lgkmcnt(10)
    v_mfma_f32_16x16x32_bf16 v[36:39], v[80:83], v[104:107], v[36:39]
    v_exp_f32 v114, v114
    v_exp_f32 v115, v115
    s_waitcnt lgkmcnt(8)
    v_mfma_f32_16x16x32_bf16 v[40:43], v[84:87], v[104:107], v[40:43]
    v_exp_f32 v116, v116
    v_exp_f32 v117, v117
    v_mfma_f32_16x16x32_bf16 v[44:47], v[32:35], v[104:107], v[44:47]
    ds_read_b64 v[72:73], v7 offset:6144
    ds_read_b64 v[74:75], v7 offset:7168
    ds_read_b64 v[76:77], v7 offset:6656
    ds_read_b64 v[78:79], v7 offset:7680
    v_exp_f32 v118, v118
    v_exp_f32 v119, v119
    s_cmp_lg_u32 s58, 0
    s_cbranch_scc1 L_SK2
    s_add_u32 m0, s61, 32768
    s_add_u32 s33, s100, 8
    s_and_b32 s33, s33, 7
    s_lshl_b32 s33, s33, 17
    s_add_u32 s33, s33, s60
    s_add_u32 s33, s33, 0x100000
    buffer_load_dwordx4 v10, s[44:47], s33 offen lds
    s_add_u32 m0, s61, 40960
    s_add_u32 s33, s100, 10
    s_and_b32 s33, s33, 7
    s_lshl_b32 s33, s33, 17
    s_add_u32 s33, s33, s60
    s_add_u32 s33, s33, 0x100000
    buffer_load_dwordx4 v10, s[44:47], s33 offen lds
L_SK2:
    s_cmp_lg_u32 s58, 0
    s_cbranch_scc1 L_OOL2
L_OOLR2:
    s_cmp_eq_u32 s38, 8
    s_cbranch_scc1 L_CTR8
L_CT8:
    v_mfma_f32_16x16x32_bf16 v[104:107], v[128:131], v[16:19], v[48:51]
    ds_read_b128 v[128:131], v6 offset:14336
    v_cvt_pk_bf16_f32 v112, v112, v113
    v_cvt_pk_bf16_f32 v113, v114, v115
    s_cmp_eq_u32 s38, 9
    s_cbranch_scc1 L_CTR9
L_CT9:
    v_mfma_f32_16x16x32_bf16 v[108:111], v[132:135], v[16:19], v[48:51]
    ds_read_b128 v[132:135], v6 offset:15360
    v_cvt_pk_bf16_f32 v114, v116, v117
    v_cvt_pk_bf16_f32 v115, v118, v119
    v_exp_f32 v96, v96
    v_exp_f32 v97, v97
    s_waitcnt lgkmcnt(10)
    v_mfma_f32_16x16x32_bf16 v[36:39], v[88:91], v[112:115], v[36:39]
    v_exp_f32 v98, v98
    v_exp_f32 v99, v99
    s_waitcnt lgkmcnt(8)
    v_mfma_f32_16x16x32_bf16 v[40:43], v[92:95], v[112:115], v[40:43]
    v_exp_f32 v100, v100
    v_exp_f32 v101, v101
    v_mfma_f32_16x16x32_bf16 v[44:47], v[32:35], v[112:115], v[44:47]
    ds_read_b64 v[80:81], v7 offset:8192
    ds_read_b64 v[82:83], v7 offset:9216
    ds_read_b64 v[84:85], v7 offset:8704
    ds_read_b64 v[86:87], v7 offset:9728
    v_exp_f32 v102, v102
    v_exp_f32 v103, v103
    s_cmp_lg_u32 s58, 0
    s_cbranch_scc1 L_SK3
    s_add_u32 m0, s61, 49152
    s_add_u32 s33, s100, 12
    s_and_b32 s33, s33, 7
    s_lshl_b32 s33, s33, 17
    s_add_u32 s33, s33, s60
    s_add_u32 s33, s33, 0x100000
    buffer_load_dwordx4 v10, s[44:47], s33 offen lds
    s_cmp_eq_u32 s24, 7
    s_cbranch_scc1 L_SK3
    s_add_u32 m0, s61, 57344
    s_add_u32 s33, s100, 14
    s_and_b32 s33, s33, 7
    s_lshl_b32 s33, s33, 17
    s_add_u32 s33, s33, s60
    s_add_u32 s33, s33, 0x100000
    buffer_load_dwordx4 v10, s[44:47], s33 offen lds
L_SK3:
    s_cmp_eq_u32 s38, 10
    s_cbranch_scc1 L_CTR10
L_CT10:
    v_mfma_f32_16x16x32_bf16 v[112:115], v[136:139], v[16:19], v[48:51]
    ds_read_b128 v[136:139], v6 offset:16384
    v_cvt_pk_bf16_f32 v96, v96, v97
    v_cvt_pk_bf16_f32 v97, v98, v99
    s_cmp_eq_u32 s38, 11
    s_cbranch_scc1 L_CTR11
L_CT11:
    v_mfma_f32_16x16x32_bf16 v[116:119], v[140:143], v[16:19], v[48:51]
    v_cvt_pk_bf16_f32 v98, v100, v101
    v_cvt_pk_bf16_f32 v99, v102, v103
    v_exp_f32 v104, v104
    v_exp_f32 v105, v105
    s_waitcnt lgkmcnt(9)
    v_mfma_f32_16x16x32_bf16 v[36:39], v[72:75], v[96:99], v[36:39]
    v_exp_f32 v106, v106
    v_exp_f32 v107, v107
    s_waitcnt lgkmcnt(7)
    v_mfma_f32_16x16x32_bf16 v[40:43], v[76:79], v[96:99], v[40:43]
    v_exp_f32 v108, v108
    v_exp_f32 v109, v109
    v_mfma_f32_16x16x32_bf16 v[44:47], v[32:35], v[96:99], v[44:47]
    ds_read_b64 v[88:89], v7 offset:10240
    ds_read_b64 v[90:91], v7 offset:11264
    ds_read_b64 v[92:93], v7 offset:10752
    ds_read_b64 v[94:95], v7 offset:11776
    v_exp_f32 v110, v110
    v_exp_f32 v111, v111
    s_cmp_eq_u32 s38, 12
    s_cbranch_scc1 L_CTR12
L_CT12:
    v_mfma_f32_16x16x32_bf16 v[96:99], v[120:123], v[16:19], v[48:51]
    v_cvt_pk_bf16_f32 v104, v104, v105
    v_cvt_pk_bf16_f32 v105, v106, v107
    s_cmp_eq_u32 s38, 13
    s_cbranch_scc1 L_CTR13
L_CT13:
    v_mfma_f32_16x16x32_bf16 v[100:103], v[124:127], v[16:19], v[48:51]
    v_cvt_pk_bf16_f32 v106, v108, v109
    v_cvt_pk_bf16_f32 v107, v110, v111
    v_exp_f32 v112, v112
    v_exp_f32 v113, v113
    s_waitcnt lgkmcnt(7)
    v_mfma_f32_16x16x32_bf16 v[36:39], v[80:83], v[104:107], v[36:39]
    v_exp_f32 v114, v114
    v_exp_f32 v115, v115
    s_waitcnt lgkmcnt(5)
    v_mfma_f32_16x16x32_bf16 v[40:43], v[84:87], v[104:107], v[40:43]
    v_exp_f32 v116, v116
    v_exp_f32 v117, v117
    v_mfma_f32_16x16x32_bf16 v[44:47], v[32:35], v[104:107], v[44:47]
    ds_read_b64 v[72:73], v7 offset:12288
    ds_read_b64 v[74:75], v7 offset:13312
    ds_read_b64 v[76:77], v7 offset:12800
    ds_read_b64 v[78:79], v7 offset:13824
    v_exp_f32 v118, v118
    v_exp_f32 v119, v119
    s_cmp_eq_u32 s38, 14
    s_cbranch_scc1 L_CTR14
L_CT14:
    v_mfma_f32_16x16x32_bf16 v[104:107], v[128:131], v[16:19], v[48:51]
    v_cvt_pk_bf16_f32 v112, v112, v113
    v_cvt_pk_bf16_f32 v113, v114, v115
    s_cmp_eq_u32 s38, 15
    s_cbranch_scc1 L_CTR15
L_CT15:
    v_mfma_f32_16x16x32_bf16 v[108:111], v[132:135], v[16:19], v[48:51]
    v_cvt_pk_bf16_f32 v114, v116, v117
    v_cvt_pk_bf16_f32 v115, v118, v119
    v_exp_f32 v96, v96
    v_exp_f32 v97, v97
    s_waitcnt lgkmcnt(6)
    v_mfma_f32_16x16x32_bf16 v[36:39], v[88:91], v[112:115], v[36:39]
    v_exp_f32 v98, v98
    v_exp_f32 v99, v99
    s_waitcnt lgkmcnt(4)
    v_mfma_f32_16x16x32_bf16 v[40:43], v[92:95], v[112:115], v[40:43]
    v_exp_f32 v100, v100
    v_exp_f32 v101, v101
    v_mfma_f32_16x16x32_bf16 v[44:47], v[32:35], v[112:115], v[44:47]
    ds_read_b64 v[80:81], v7 offset:14336
    ds_read_b64 v[82:83], v7 offset:15360
    ds_read_b64 v[84:85], v7 offset:14848
    ds_read_b64 v[86:87], v7 offset:15872
    v_exp_f32 v102, v102
    v_exp_f32 v103, v103
    buffer_load_dword v9, v11, s[20:23], s96 offen sc1
    v_mfma_f32_16x16x32_bf16 v[112:115], v[136:139], v[16:19], v[28:31]
    v_cvt_pk_bf16_f32 v96, v96, v97
    v_cvt_pk_bf16_f32 v97, v98, v99
    v_cvt_pk_bf16_f32 v98, v100, v101
    v_cvt_pk_bf16_f32 v99, v102, v103
    v_exp_f32 v104, v104
    v_exp_f32 v105, v105
    s_waitcnt lgkmcnt(6)
    v_mfma_f32_16x16x32_bf16 v[36:39], v[72:75], v[96:99], v[36:39]
    v_exp_f32 v106, v106
    v_exp_f32 v107, v107
    s_waitcnt lgkmcnt(4)
    v_mfma_f32_16x16x32_bf16 v[40:43], v[76:79], v[96:99], v[40:43]
    v_exp_f32 v108, v108
    v_exp_f32 v109, v109
    v_mfma_f32_16x16x32_bf16 v[44:47], v[32:35], v[96:99], v[44:47]
    ds_read_b64 v[88:89], v7 offset:16384
    ds_read_b64 v[92:93], v7 offset:16896
    v_exp_f32 v110, v110
    v_exp_f32 v111, v111
    v_cvt_pk_bf16_f32 v104, v104, v105
    v_cvt_pk_bf16_f32 v105, v106, v107
    v_cvt_pk_bf16_f32 v106, v108, v109
    v_cvt_pk_bf16_f32 v107, v110, v111
    v_exp_f32 v112, v112
    v_exp_f32 v113, v113
    s_waitcnt lgkmcnt(4)
    v_mfma_f32_16x16x32_bf16 v[36:39], v[80:83], v[104:107], v[36:39]
    v_exp_f32 v114, v114
    v_exp_f32 v115, v115
    s_waitcnt lgkmcnt(2)
    v_mfma_f32_16x16x32_bf16 v[40:43], v[84:87], v[104:107], v[40:43]
    v_mfma_f32_16x16x32_bf16 v[44:47], v[32:35], v[104:107], v[44:47]
    v_cvt_pk_bf16_f32 v112, v112, v113
    v_cvt_pk_bf16_f32 v113, v114, v115
    s_waitcnt lgkmcnt(1)
    s_nop 0
    v_mfma_f32_16x16x16_bf16 v[36:39], v[88:89], v[112:113], v[36:39]
    s_waitcnt lgkmcnt(0)
    v_mfma_f32_16x16x16_bf16 v[40:43], v[92:93], v[112:113], v[40:43]
    v_mfma_f32_16x16x16_bf16 v[44:47], v[32:33], v[112:113], v[44:47]
    s_setprio 0
    s_nop 6
    v_add_f32_e64 v52, |v36|, |v37|
    v_add_f32_e64 v53, |v38|, |v39|
    v_add_f32_e64 v52, |v40|, v52
    v_add_f32_e64 v53, |v41|, v53
    v_add_f32_e64 v52, |v42|, v52
    v_add_f32_e64 v53, |v43|, v53
    v_cmp_nle_f32 vcc, v54, v44
    v_cmp_nge_f32 s[34:35], v55, v44
    v_add_f32 v52, v52, v53
    s_or_b64 s[34:35], s[34:35], vcc
    v_cmp_nge_f32 vcc, 0x7f000000, v52
    s_or_b64 s[34:35], s[34:35], vcc
    s_cmp_eq_u64 s[34:35], 0
    s_cbranch_scc1 L_FASTOK
    ds_read_b128 v[56:59], v6 offset:0
    ds_read_b128 v[60:63], v6 offset:1024
    ds_read_b128 v[64:67], v6 offset:2048
    ds_read_b128 v[68:71], v6 offset:3072
    s_waitcnt lgkmcnt(3)
    v_mfma_f32_16x16x32_bf16 v[96:99], v[56:59], v[16:19], v[24:27]
    ds_read_b128 v[56:59], v6 offset:4096
    s_waitcnt lgkmcnt(3)
    v_mfma_f32_16x16x32_bf16 v[100:103], v[60:63], v[16:19], 0
    ds_read_b128 v[60:63], v6 offset:5120
    s_waitcnt lgkmcnt(3)
    v_mfma_f32_16x16x32_bf16 v[104:107], v[64:67], v[16:19], 0
    ds_read_b128 v[64:67], v6 offset:6144
    s_waitcnt lgkmcnt(3)
    v_mfma_f32_16x16x32_bf16 v[108:111], v[68:71], v[16:19], 0
    ds_read_b128 v[68:71], v6 offset:7168
    s_waitcnt lgkmcnt(3)
    v_mfma_f32_16x16x32_bf16 v[112:115], v[56:59], v[16:19], 0
    ds_read_b128 v[56:59], v6 offset:8192
    s_waitcnt lgkmcnt(3)
    v_mfma_f32_16x16x32_bf16 v[116:119], v[60:63], v[16:19], 0
    ds_read_b128 v[60:63], v6 offset:9216
    s_waitcnt lgkmcnt(3)
    v_mfma_f32_16x16x32_bf16 v[120:123], v[64:67], v[16:19], 0
    ds_read_b128 v[64:67], v6 offset:10240
    s_waitcnt lgkmcnt(3)
    v_mfma_f32_16x16x32_bf16 v[124:127], v[68:71], v[16:19], 0
    ds_read_b128 v[68:71], v6 offset:11264
    s_waitcnt lgkmcnt(3)
    v_mfma_f32_16x16x32_bf16 v[128:131], v[56:59], v[16:19], 0
    ds_read_b128 v[56:59], v6 offset:12288
    s_waitcnt lgkmcnt(3)
    v_mfma_f32_16x16x32_bf16 v[132:135], v[60:63], v[16:19], 0
    ds_read_b128 v[60:63], v6 offset:13312
    s_waitcnt lgkmcnt(3)
    v_mfma_f32_16x16x32_bf16 v[136:139], v[64:67], v[16:19], 0
    ds_read_b128 v[64:67], v6 offset:14336
    s_waitcnt lgkmcnt(3)
    v_mfma_f32_16x16x32_bf16 v[140:143], v[68:71], v[16:19], 0
    ds_read_b128 v[68:71], v6 offset:15360
    s_waitcnt lgkmcnt(3)
    v_mfma_f32_16x16x32_bf16 v[144:147], v[56:59], v[16:19], 0
    ds_read_b128 v[56:59], v6 offset:16384
    s_waitcnt lgkmcnt(3)
    v_mfma_f32_16x16x32_bf16 v[148:151], v[60:63], v[16:19], 0
    s_waitcnt lgkmcnt(2)
    v_mfma_f32_16x16x32_bf16 v[152:155], v[64:67], v[16:19], 0
    s_waitcnt lgkmcnt(1)
    v_mfma_f32_16x16x32_bf16 v[156:159], v[68:71], v[16:19], 0
    s_waitcnt lgkmcnt(0)
    v_mfma_f32_16x16x32_bf16 v[160:163], v[56:59], v[16:19], v[28:31]
    ds_read_b64 v[72:73], v7 offset:0
    ds_read_b64 v[74:75], v7 offset:1024
    ds_read_b64 v[76:77], v7 offset:512
    ds_read_b64 v[78:79], v7 offset:1536
    ds_read_b64 v[80:81], v7 offset:2048
    ds_read_b64 v[82:83], v7 offset:3072
    ds_read_b64 v[84:85], v7 offset:2560
    ds_read_b64 v[86:87], v7 offset:3584
    s_nop 7
    s_cmp_eq_u32 s38, 0
    s_cbranch_scc1 L_NOFIX
    v_mov_b32 v96, v5
    v_mov_b32 v97, v5
    v_mov_b32 v98, v5
    v_mov_b32 v99, v5
    s_cmp_eq_u32 s38, 1
    s_cbranch_scc1 L_NOFIX
    v_mov_b32 v100, v5
    v_mov_b32 v101, v5
    v_mov_b32 v102, v5
    v_mov_b32 v103, v5
    s_cmp_eq_u32 s38, 2
    s_cbranch_scc1 L_NOFIX
    v_mov_b32 v104, v5
    v_mov_b32 v105, v5
    v_mov_b32 v106, v5
    v_mov_b32 v107, v5
    s_cmp_eq_u32 s38, 3
    s_cbranch_scc1 L_NOFIX
    v_mov_b32 v108, v5
    v_mov_b32 v109, v5
    v_mov_b32 v110, v5
    v_mov_b32 v111, v5
    s_cmp_eq_u32 s38, 4
    s_cbranch_scc1 L_NOFIX
    v_mov_b32 v112, v5
    v_mov_b32 v113, v5
    v_mov_b32 v114, v5
    v_mov_b32 v115, v5
    s_cmp_eq_u32 s38, 5
    s_cbranch_scc1 L_NOFIX
    v_mov_b32 v116, v5
    v_mov_b32 v117, v5
    v_mov_b32 v118, v5
    v_mov_b32 v119, v5
    s_cmp_eq_u32 s38, 6
    s_cbranch_scc1 L_NOFIX
    v_mov_b32 v120, v5
    v_mov_b32 v121, v5
    v_mov_b32 v122, v5
    v_mov_b32 v123, v5
    s_cmp_eq_u32 s38, 7
    s_cbranch_scc1 L_NOFIX
    v_mov_b32 v124, v5
    v_mov_b32 v125, v5
    v_mov_b32 v126, v5
    v_mov_b32 v127, v5
    s_cmp_eq_u32 s38, 8
    s_cbranch_scc1 L_NOFIX
    v_mov_b32 v128, v5
    v_mov_b32 v129, v5
    v_mov_b32 v130, v5
    v_mov_b32 v131, v5
    s_cmp_eq_u32 s38, 9
    s_cbranch_scc1 L_NOFIX
    v_mov_b32 v132, v5
    v_mov_b32 v133, v5
    v_mov_b32 v134, v5
    v_mov_b32 v135, v5
    s_cmp_eq_u32 s38, 10
    s_cbranch_scc1 L_NOFIX
    v_mov_b32 v136, v5
    v_mov_b32 v137, v5
    v_mov_b32 v138, v5
    v_mov_b32 v139, v5
    s_cmp_eq_u32 s38, 11
    s_cbranch_scc1 L_NOFIX
    v_mov_b32 v140, v5
    v_mov_b32 v141, v5
    v_mov_b32 v142, v5
    v_mov_b32 v143, v5
    s_cmp_eq_u32 s38, 12
    s_cbranch_scc1 L_NOFIX
    v_mov_b32 v144, v5
    v_mov_b32 v145, v5
    v_mov_b32 v146, v5
    v_mov_b32 v147, v5
    s_cmp_eq_u32 s38, 13
    s_cbranch_scc1 L_NOFIX
    v_mov_b32 v148, v5
    v_mov_b32 v149, v5
    v_mov_b32 v150, v5
    v_mov_b32 v151, v5
    s_cmp_eq_u32 s38, 14
    s_cbranch_scc1 L_NOFIX
    v_mov_b32 v152, v5
    v_mov_b32 v153, v5
    v_mov_b32 v154, v5
    v_mov_b32 v155, v5
    s_cmp_eq_u32 s38, 15
    s_cbranch_scc1 L_NOFIX
    v_mov_b32 v156, v5
    v_mov_b32 v157, v5
    v_mov_b32 v158, v5
    v_mov_b32 v159, v5
L_NOFIX:
    v_max_f32 v52, v96, v97
    v_max_f32 v53, v98, v99
    v_max3_f32 v52, v52, v100, v101
    v_max3_f32 v53, v53, v102, v103
    v_max3_f32 v52, v52, v104, v105
    v_max3_f32 v53, v53, v106, v107
    v_max3_f32 v52, v52, v108, v109
    v_max3_f32 v53, v53, v110, v111
    v_max3_f32 v52, v52, v112, v113
    v_max3_f32 v53, v53, v114, v115
    v_max3_f32 v52, v52, v116, v117
    v_max3_f32 v53, v53, v118, v119
    v_max3_f32 v52, v52, v120, v121
    v_max3_f32 v53, v53, v122, v123
    v_max3_f32 v52, v52, v124, v125
    v_max3_f32 v53, v53, v126, v127
    v_max3_f32 v52, v52, v128, v129
    v_max3_f32 v53, v53, v130, v131
    v_max3_f32 v52, v52, v132, v133
    v_max3_f32 v53, v53, v134, v135
    v_max3_f32 v52, v52, v136, v137
    v_max3_f32 v53, v53, v138, v139
    v_max3_f32 v52, v52, v140, v141
    v_max3_f32 v53, v53, v142, v143
    v_max3_f32 v52, v52, v144, v145
    v_max3_f32 v53, v53, v146, v147
    v_max3_f32 v52, v52, v148, v149
    v_max3_f32 v53, v53, v150, v151
    v_max3_f32 v52, v52, v152, v153
    v_max3_f32 v53, v53, v154, v155
    v_max3_f32 v52, v52, v156, v157
    v_max3_f32 v53, v53, v158, v159
    v_max3_f32 v52, v52, v160, v161
    v_max3_f32 v53, v53, v162, v163
    v_max_f32 v52, v52, v53
    v_mov_b32 v53, v52
    s_nop 1
    v_permlane32_swap_b32 v52, v53
    v_max_f32 v52, v52, v53
    v_mov_b32 v53, v52
    s_nop 1
    v_permlane16_swap_b32 v52, v53
    v_max_f32 v52, v52, v53
    v_sub_f32 v96, v96, v52
    v_sub_f32 v97, v97, v52
    v_sub_f32 v98, v98, v52
    v_sub_f32 v99, v99, v52
    v_sub_f32 v100, v100, v52
    v_sub_f32 v101, v101, v52
    v_sub_f32 v102, v102, v52
    v_sub_f32 v103, v103, v52
    v_exp_f32 v96, v96
    v_exp_f32 v97, v97
    v_exp_f32 v98, v98
    v_exp_f32 v99, v99
    v_exp_f32 v100, v100
    v_exp_f32 v101, v101
    v_exp_f32 v102, v102
    v_exp_f32 v103, v103
    v_cvt_pk_bf16_f32 v96, v96, v97
    v_cvt_pk_bf16_f32 v97, v98, v99
    v_cvt_pk_bf16_f32 v98, v100, v101
    v_cvt_pk_bf16_f32 v99, v102, v103
    s_waitcnt lgkmcnt(6)
    s_nop 0
    v_mfma_f32_16x16x32_bf16 v[36:39], v[72:75], v[96:99], 0
    s_waitcnt lgkmcnt(4)
    v_mfma_f32_16x16x32_bf16 v[40:43], v[76:79], v[96:99], 0
    v_mfma_f32_16x16x32_bf16 v[44:47], v[32:35], v[96:99], 0
    ds_read_b64 v[88:89], v7 offset:4096
    ds_read_b64 v[90:91], v7 offset:5120
    ds_read_b64 v[92:93], v7 offset:4608
    ds_read_b64 v[94:95], v7 offset:5632
    v_sub_f32 v104, v104, v52
    v_sub_f32 v105, v105, v52
    v_sub_f32 v106, v106, v52
    v_sub_f32 v107, v107, v52
    v_sub_f32 v108, v108, v52
    v_sub_f32 v109, v109, v52
    v_sub_f32 v110, v110, v52
    v_sub_f32 v111, v111, v52
    v_exp_f32 v104, v104
    v_exp_f32 v105, v105
    v_exp_f32 v106, v106
    v_exp_f32 v107, v107
    v_exp_f32 v108, v108
    v_exp_f32 v109, v109
    v_exp_f32 v110, v110
    v_exp_f32 v111, v111
    v_cvt_pk_bf16_f32 v104, v104, v105
    v_cvt_pk_bf16_f32 v105, v106, v107
    v_cvt_pk_bf16_f32 v106, v108, v109
    v_cvt_pk_bf16_f32 v107, v110, v111
    s_waitcnt lgkmcnt(6)
    s_nop 0
    v_mfma_f32_16x16x32_bf16 v[36:39], v[80:83], v[104:107], v[36:39]
    s_waitcnt lgkmcnt(4)
    v_mfma_f32_16x16x32_bf16 v[40:43], v[84:87], v[104:107], v[40:43]
    v_mfma_f32_16x16x32_bf16 v[44:47], v[32:35], v[104:107], v[44:47]
    ds_read_b64 v[72:73], v7 offset:6144
    ds_read_b64 v[74:75], v7 offset:7168
    ds_read_b64 v[76:77], v7 offset:6656
    ds_read_b64 v[78:79], v7 offset:7680
    v_sub_f32 v112, v112, v52
    v_sub_f32 v113, v113, v52
    v_sub_f32 v114, v114, v52
    v_sub_f32 v115, v115, v52
    v_sub_f32 v116, v116, v52
    v_sub_f32 v117, v117, v52
    v_sub_f32 v118, v118, v52
    v_sub_f32 v119, v119, v52
    v_exp_f32 v112, v112
    v_exp_f32 v113, v113
    v_exp_f32 v114, v114
    v_exp_f32 v115, v115
    v_exp_f32 v116, v116
    v_exp_f32 v117, v117
    v_exp_f32 v118, v118
    v_exp_f32 v119, v119
    v_cvt_pk_bf16_f32 v112, v112, v113
    v_cvt_pk_bf16_f32 v113, v114, v115
    v_cvt_pk_bf16_f32 v114, v116, v117
    v_cvt_pk_bf16_f32 v115, v118, v119
    s_waitcnt lgkmcnt(6)
    s_nop 0
    v_mfma_f32_16x16x32_bf16 v[36:39], v[88:91], v[112:115], v[36:39]
    s_waitcnt lgkmcnt(4)
    v_mfma_f32_16x16x32_bf16 v[40:43], v[92:95], v[112:115], v[40:43]
    v_mfma_f32_16x16x32_bf16 v[44:47], v[32:35], v[112:115], v[44:47]
    ds_read_b64 v[80:81], v7 offset:8192
    ds_read_b64 v[82:83], v7 offset:9216
    ds_read_b64 v[84:85], v7 offset:8704
    ds_read_b64 v[86:87], v7 offset:9728
    v_sub_f32 v120, v120, v52
    v_sub_f32 v121, v121, v52
    v_sub_f32 v122, v122, v52
    v_sub_f32 v123, v123, v52
    v_sub_f32 v124, v124, v52
    v_sub_f32 v125, v125, v52
    v_sub_f32 v126, v126, v52
    v_sub_f32 v127, v127, v52
    v_exp_f32 v120, v120
    v_exp_f32 v121, v121
    v_exp_f32 v122, v122
    v_exp_f32 v123, v123
    v_exp_f32 v124, v124
    v_exp_f32 v125, v125
    v_exp_f32 v126, v126
    v_exp_f32 v127, v127
    v_cvt_pk_bf16_f32 v120, v120, v121
    v_cvt_pk_bf16_f32 v121, v122, v123
    v_cvt_pk_bf16_f32 v122, v124, v125
    v_cvt_pk_bf16_f32 v123, v126, v127
    s_waitcnt lgkmcnt(6)
    s_nop 0
    v_mfma_f32_16x16x32_bf16 v[36:39], v[72:75], v[120:123], v[36:39]
    s_waitcnt lgkmcnt(4)
    v_mfma_f32_16x16x32_bf16 v[40:43], v[76:79], v[120:123], v[40:43]
    v_mfma_f32_16x16x32_bf16 v[44:47], v[32:35], v[120:123], v[44:47]
    ds_read_b64 v[88:89], v7 offset:10240
    ds_read_b64 v[90:91], v7 offset:11264
    ds_read_b64 v[92:93], v7 offset:10752
    ds_read_b64 v[94:95], v7 offset:11776
    v_sub_f32 v128, v128, v52
    v_sub_f32 v129, v129, v52
    v_sub_f32 v130, v130, v52
    v_sub_f32 v131, v131, v52
    v_sub_f32 v132, v132, v52
    v_sub_f32 v133, v133, v52
    v_sub_f32 v134, v134, v52
    v_sub_f32 v135, v135, v52
    v_exp_f32 v128, v128
    v_exp_f32 v129, v129
    v_exp_f32 v130, v130
    v_exp_f32 v131, v131
    v_exp_f32 v132, v132
    v_exp_f32 v133, v133
    v_exp_f32 v134, v134
    v_exp_f32 v135, v135
    v_cvt_pk_bf16_f32 v128, v128, v129
    v_cvt_pk_bf16_f32 v129, v130, v131
    v_cvt_pk_bf16_f32 v130, v132, v133
    v_cvt_pk_bf16_f32 v131, v134, v135
    s_waitcnt lgkmcnt(6)
    s_nop 0
    v_mfma_f32_16x16x32_bf16 v[36:39], v[80:83], v[128:131], v[36:39]
    s_waitcnt lgkmcnt(4)
    v_mfma_f32_16x16x32_bf16 v[40:43], v[84:87], v[128:131], v[40:43]
    v_mfma_f32_16x16x32_bf16 v[44:47], v[32:35], v[128:131], v[44:47]
    ds_read_b64 v[72:73], v7 offset:12288
    ds_read_b64 v[74:75], v7 offset:13312
    ds_read_b64 v[76:77], v7 offset:12800
    ds_read_b64 v[78:79], v7 offset:13824
    v_sub_f32 v136, v136, v52
    v_sub_f32 v137, v137, v52
    v_sub_f32 v138, v138, v52
    v_sub_f32 v139, v139, v52
    v_sub_f32 v140, v140, v52
    v_sub_f32 v141, v141, v52
    v_sub_f32 v142, v142, v52
    v_sub_f32 v143, v143, v52
    v_exp_f32 v136, v136
    v_exp_f32 v137, v137
    v_exp_f32 v138, v138
    v_exp_f32 v139, v139
    v_exp_f32 v140, v140
    v_exp_f32 v141, v141
    v_exp_f32 v142, v142
    v_exp_f32 v143, v143
    v_cvt_pk_bf16_f32 v136, v136, v137
    v_cvt_pk_bf16_f32 v137, v138, v139
    v_cvt_pk_bf16_f32 v138, v140, v141
    v_cvt_pk_bf16_f32 v139, v142, v143
    s_waitcnt lgkmcnt(6)
    s_nop 0
    v_mfma_f32_16x16x32_bf16 v[36:39], v[88:91], v[136:139], v[36:39]
    s_waitcnt lgkmcnt(4)
    v_mfma_f32_16x16x32_bf16 v[40:43], v[92:95], v[136:139], v[40:43]
    v_mfma_f32_16x16x32_bf16 v[44:47], v[32:35], v[136:139], v[44:47]
    ds_read_b64 v[80:81], v7 offset:14336
    ds_read_b64 v[82:83], v7 offset:15360
    ds_read_b64 v[84:85], v7 offset:14848
    ds_read_b64 v[86:87], v7 offset:15872
    v_sub_f32 v144, v144, v52
    v_sub_f32 v145, v145, v52
    v_sub_f32 v146, v146, v52
    v_sub_f32 v147, v147, v52
    v_sub_f32 v148, v148, v52
    v_sub_f32 v149, v149, v52
    v_sub_f32 v150, v150, v52
    v_sub_f32 v151, v151, v52
    v_exp_f32 v144, v144
    v_exp_f32 v145, v145
    v_exp_f32 v146, v146
    v_exp_f32 v147, v147
    v_exp_f32 v148, v148
    v_exp_f32 v149, v149
    v_exp_f32 v150, v150
    v_exp_f32 v151, v151
    v_cvt_pk_bf16_f32 v144, v144, v145
    v_cvt_pk_bf16_f32 v145, v146, v147
    v_cvt_pk_bf16_f32 v146, v148, v149
    v_cvt_pk_bf16_f32 v147, v150, v151
    s_waitcnt lgkmcnt(6)
    s_nop 0
    v_mfma_f32_16x16x32_bf16 v[36:39], v[72:75], v[144:147], v[36:39]
    s_waitcnt lgkmcnt(4)
    v_mfma_f32_16x16x32_bf16 v[40:43], v[76:79], v[144:147], v[40:43]
    v_mfma_f32_16x16x32_bf16 v[44:47], v[32:35], v[144:147], v[44:47]
    ds_read_b64 v[88:89], v7 offset:16384
    ds_read_b64 v[92:93], v7 offset:16896
    v_sub_f32 v152, v152, v52
    v_sub_f32 v153, v153, v52
    v_sub_f32 v154, v154, v52
    v_sub_f32 v155, v155, v52
    v_sub_f32 v156, v156, v52
    v_sub_f32 v157, v157, v52
    v_sub_f32 v158, v158, v52
    v_sub_f32 v159, v159, v52
    v_exp_f32 v152, v152
    v_exp_f32 v153, v153
    v_exp_f32 v154, v154
    v_exp_f32 v155, v155
    v_exp_f32 v156, v156
    v_exp_f32 v157, v157
    v_exp_f32 v158, v158
    v_exp_f32 v159, v159
    v_cvt_pk_bf16_f32 v152, v152, v153
    v_cvt_pk_bf16_f32 v153, v154, v155
    v_cvt_pk_bf16_f32 v154, v156, v157
    v_cvt_pk_bf16_f32 v155, v158, v159
    s_waitcnt lgkmcnt(4)
    s_nop 0
    v_mfma_f32_16x16x32_bf16 v[36:39], v[80:83], v[152:155], v[36:39]
    s_waitcnt lgkmcnt(2)
    v_mfma_f32_16x16x32_bf16 v[40:43], v[84:87], v[152:155], v[40:43]
    v_mfma_f32_16x16x32_bf16 v[44:47], v[32:35], v[152:155], v[44:47]
    v_sub_f32 v160, v160, v52
    v_sub_f32 v161, v161, v52
    v_sub_f32 v162, v162, v52
    v_sub_f32 v163, v163, v52
    v_exp_f32 v160, v160
    v_exp_f32 v161, v161
    v_exp_f32 v162, v162
    v_exp_f32 v163, v163
    v_cvt_pk_bf16_f32 v160, v160, v161
    v_cvt_pk_bf16_f32 v161, v162, v163
    s_waitcnt lgkmcnt(1)
    s_nop 0
    v_mfma_f32_16x16x16_bf16 v[36:39], v[88:89], v[160:161], v[36:39]
    s_waitcnt lgkmcnt(0)
    v_mfma_f32_16x16x16_bf16 v[40:43], v[92:93], v[160:161], v[40:43]
    v_mfma_f32_16x16x16_bf16 v[44:47], v[32:33], v[160:161], v[44:47]
    s_nop 7
L_FASTOK:
    v_rcp_f32 v52, v44
    s_nop 0
    v_mul_f32 v36, v36, v52
    v_mul_f32 v37, v37, v52
    v_mul_f32 v38, v38, v52
    v_mul_f32 v39, v39, v52
    v_mul_f32 v40, v40, v52
    v_mul_f32 v41, v41, v52
    v_mul_f32 v42, v42, v52
    v_mul_f32 v43, v43, v52
    v_cvt_pk_bf16_f32 v96, v36, v37
    v_cvt_pk_bf16_f32 v97, v38, v39
    v_cvt_pk_bf16_f32 v98, v40, v41
    v_cvt_pk_bf16_f32 v99, v42, v43
    buffer_store_dwordx4 v[96:99], v1, s[20:23], s37 offen sc1
    s_add_u32 s37, s37, 1024
    v_add_u32 v6, 49152, v6
    v_add_u32 v7, 49152, v7
    v_mov_b32 v16, v20
    v_mov_b32 v17, v21
    v_mov_b32 v18, v22
    v_mov_b32 v19, v23
    s_cmp_lg_u32 s58, 0
    s_cbranch_scc1 L_RDONE
    s_mov_b32 s58, 1
    s_branch L_ROUND
L_RDONE:
    s_cmp_eq_u32 s10, 1
    s_cbranch_scc1 L_E2NO
    s_waitcnt vmcnt(1)
    v_cmp_ne_u32 vcc, 1, v9
    s_cmp_lg_u64 vcc, 0
    s_cbranch_scc1 L_E2NO
    s_add_u32 s34, s101, 0
    s_and_b32 s34, s34, 7
    s_lshl_b32 s34, s34, 11
    s_add_u32 s33, s97, s34
    buffer_load_dwordx4 v[164:167], v1, s[20:23], s33 offen offset:0 sc1
    s_add_u32 s33, s98, s34
    buffer_load_dwordx4 v[168:171], v1, s[20:23], s33 offen offset:0 sc1
    s_add_u32 s34, s101, 1
    s_and_b32 s34, s34, 7
    s_lshl_b32 s34, s34, 11
    s_add_u32 s33, s97, s34
    buffer_load_dwordx4 v[172:175], v1, s[20:23], s33 offen offset:0 sc1
    s_add_u32 s33, s98, s34
    buffer_load_dwordx4 v[176:179], v1, s[20:23], s33 offen offset:0 sc1
    s_mov_b32 s99, 1
    s_waitcnt vmcnt(4)
    s_branch L_E2J
L_E2NO:
    s_waitcnt vmcnt(0)
L_E2J:
    s_barrier
    s_cmp_lg_u32 s24, 0
    s_cbranch_scc1 L_NOSIG1
    s_mov_b64 exec, 1
    v_mov_b32 v2, 1
    v_mov_b32 v3, 0
    buffer_store_dword v2, v3, s[20:23], s39 offen sc1
    s_mov_b64 exec, -1
L_NOSIG1:
    s_add_u32 s39, s39, 128
    v_mov_b32 v15, v11
    v_and_b32 v12, 15, v0
    v_lshrrev_b32 v13, 4, v0
    v_lshrrev_b32 v17, 2, v12
    v_and_b32 v18, 3, v12
    v_lshlrev_b32 v19, 2, v13
    v_add_u32 v19, v19, v17
    v_lshrrev_b32 v20, 1, v19
    v_and_b32 v20, 3, v20
    v_lshlrev_b32 v19, 7, v19
    v_lshlrev_b32 v20, 5, v20
    v_lshlrev_b32 v18, 3, v18
    v_add3_u32 v19, v19, v20, v18
    s_lshl_b32 s31, s30, 15
    v_add_u32 v19, s31, v19
    v_xor_b32 v20, 0, v19
    v_add_u32 v4, 0, v20
    v_add_u32 v8, 0x10000, v20
    v_xor_b32 v20, 32, v19
    v_add_u32 v5, 0, v20
    v_add_u32 v9, 0x10000, v20
    v_xor_b32 v20, 64, v19
    v_add_u32 v6, 0, v20
    v_add_u32 v11, 0x10000, v20
    v_xor_b32 v20, 96, v19
    v_add_u32 v7, 0, v20
    v_add_u32 v14, 0x10000, v20
    v_mov_b32 v16, 0
    v_mov_b32 v17, 0
    v_mov_b32 v18, 0
    v_mov_b32 v19, 0
    v_mov_b32 v20, 0
    v_mov_b32 v21, 0
    v_mov_b32 v22, 0
    v_mov_b32 v23, 0
    v_mov_b32 v24, 0
    v_mov_b32 v25, 0
    v_mov_b32 v26, 0
    v_mov_b32 v27, 0
    v_mov_b32 v28, 0
    v_mov_b32 v29, 0
    v_mov_b32 v30, 0
    v_mov_b32 v31, 0
    v_mov_b32 v32, 0
    v_mov_b32 v33, 0
    v_mov_b32 v34, 0
    v_mov_b32 v35, 0
    v_mov_b32 v36, 0
    v_mov_b32 v37, 0
    v_mov_b32 v38, 0
    v_mov_b32 v39, 0
    v_mov_b32 v40, 0
    v_mov_b32 v41, 0
    v_mov_b32 v42, 0
    v_mov_b32 v43, 0
    v_mov_b32 v44, 0
    v_mov_b32 v45, 0
    v_mov_b32 v46, 0
    v_mov_b32 v47, 0
    s_cmp_eq_u32 s10, 1
    s_cbranch_scc1 L_HAVEALL
    s_cmp_eq_u32 s99, 1
    s_cbranch_scc1 L_HAVEA
    s_mov_b32 s35, 200000
L_PC0:
    buffer_load_dword v2, v15, s[20:23], s96 offen sc1
    s_waitcnt vmcnt(0)
    v_cmp_ne_u32 vcc, 1, v2
    s_cmp_eq_u64 vcc, 0
    s_cbranch_scc1 L_PC0_ok
    s_sub_u32 s35, s35, 1
    s_cmp_lg_u32 s35, 0
    s_cbranch_scc1 L_PC0
L_PC0_ok:
    s_add_u32 s34, s101, 0
    s_and_b32 s34, s34, 7
    s_lshl_b32 s34, s34, 11
    s_add_u32 s33, s97, s34
    buffer_load_dwordx4 v[164:167], v1, s[20:23], s33 offen offset:0 sc1
    s_add_u32 s33, s98, s34
    buffer_load_dwordx4 v[168:171], v1, s[20:23], s33 offen offset:0 sc1
    s_add_u32 s34, s101, 1
    s_and_b32 s34, s34, 7
    s_lshl_b32 s34, s34, 11
    s_add_u32 s33, s97, s34
    buffer_load_dwordx4 v[172:175], v1, s[20:23], s33 offen offset:0 sc1
    s_add_u32 s33, s98, s34
    buffer_load_dwordx4 v[176:179], v1, s[20:23], s33 offen offset:0 sc1
L_HAVEA:
    s_add_u32 s34, s101, 2
    s_and_b32 s34, s34, 7
    s_lshl_b32 s34, s34, 11
    s_add_u32 s33, s97, s34
    buffer_load_dwordx4 v[180:183], v1, s[20:23], s33 offen offset:0 sc1
    s_add_u32 s33, s98, s34
    buffer_load_dwordx4 v[184:187], v1, s[20:23], s33 offen offset:0 sc1
    s_add_u32 s34, s101, 3
    s_and_b32 s34, s34, 7
    s_lshl_b32 s34, s34, 11
    s_add_u32 s33, s97, s34
    buffer_load_dwordx4 v[188:191], v1, s[20:23], s33 offen offset:0 sc1
    s_add_u32 s33, s98, s34
    buffer_load_dwordx4 v[192:195], v1, s[20:23], s33 offen offset:0 sc1
    s_add_u32 s34, s101, 4
    s_and_b32 s34, s34, 7
    s_lshl_b32 s34, s34, 11
    s_add_u32 s33, s97, s34
    buffer_load_dwordx4 v[196:199], v1, s[20:23], s33 offen offset:0 sc1
    s_add_u32 s33, s98, s34
    buffer_load_dwordx4 v[200:203], v1, s[20:23], s33 offen offset:0 sc1
    s_add_u32 s34, s101, 5
    s_and_b32 s34, s34, 7
    s_lshl_b32 s34, s34, 11
    s_add_u32 s33, s97, s34
    buffer_load_dwordx4 v[204:207], v1, s[20:23], s33 offen offset:0 sc1
    s_add_u32 s33, s98, s34
    buffer_load_dwordx4 v[208:211], v1, s[20:23], s33 offen offset:0 sc1
    s_add_u32 s34, s101, 6
    s_and_b32 s34, s34, 7
    s_lshl_b32 s34, s34, 11
    s_add_u32 s33, s97, s34
    buffer_load_dwordx4 v[212:215], v1, s[20:23], s33 offen offset:0 sc1
    s_add_u32 s33, s98, s34
    buffer_load_dwordx4 v[216:219], v1, s[20:23], s33 offen offset:0 sc1
    s_add_u32 s34, s101, 7
    s_and_b32 s34, s34, 7
    s_lshl_b32 s34, s34, 11
    s_add_u32 s33, s97, s34
    buffer_load_dwordx4 v[220:223], v1, s[20:23], s33 offen offset:0 sc1
    s_add_u32 s33, s98, s34
    buffer_load_dwordx4 v[224:227], v1, s[20:23], s33 offen offset:0 sc1
L_HAVEALL:
    s_cmp_lg_u32 s24, 7
    s_cbranch_scc1 L_NOC63
    s_add_u32 m0, s61, 57344
    s_add_u32 s33, s100, 14
    s_and_b32 s33, s33, 7
    s_lshl_b32 s33, s33, 17
    s_add_u32 s33, s33, s60
    s_add_u32 s33, s33, 0x100000
    buffer_load_dwordx4 v10, s[44:47], s33 offen lds
L_NOC63:
    v_and_b32 v15, 15, v0
    v_lshlrev_b32 v15, 2, v15
    s_add_u32 s96, s96, 128
    ds_read_b64_tr_b16 v[48:49], v4 offset:0
    ds_read_b64_tr_b16 v[50:51], v4 offset:2048
    ds_read_b64_tr_b16 v[52:53], v5 offset:0
    ds_read_b64_tr_b16 v[54:55], v5 offset:2048
    ds_read_b64_tr_b16 v[56:57], v6 offset:0
    ds_read_b64_tr_b16 v[58:59], v6 offset:2048
    ds_read_b64_tr_b16 v[60:61], v7 offset:0
    ds_read_b64_tr_b16 v[62:63], v7 offset:2048
    s_waitcnt vmcnt(14)
    s_waitcnt lgkmcnt(6)
    v_mfma_f32_16x16x32_bf16 v[16:19], v[48:51], v[164:167], v[16:19]
    ds_read_b64_tr_b16 v[64:65], v4 offset:4096
    s_add_u32 m0, s61, 65536
    s_add_u32 s33, s100, 0
    s_and_b32 s33, s33, 7
    s_lshl_b32 s33, s33, 17
    s_add_u32 s33, s33, s60
    s_add_u32 s33, s33, 0x10000
    buffer_load_dwordx4 v10, s[44:47], s33 offen lds
    v_mfma_f32_16x16x32_bf16 v[32:35], v[48:51], v[168:171], v[32:35]
    ds_read_b64_tr_b16 v[66:67], v4 offset:6144
    s_waitcnt lgkmcnt(6)
    v_mfma_f32_16x16x32_bf16 v[20:23], v[52:55], v[164:167], v[20:23]
    ds_read_b64_tr_b16 v[68:69], v5 offset:4096
    v_mfma_f32_16x16x32_bf16 v[36:39], v[52:55], v[168:171], v[36:39]
    ds_read_b64_tr_b16 v[70:71], v5 offset:6144
    s_add_u32 m0, s61, 73728
    s_add_u32 s33, s100, 2
    s_and_b32 s33, s33, 7
    s_lshl_b32 s33, s33, 17
    s_add_u32 s33, s33, s60
    s_add_u32 s33, s33, 0x10000
    buffer_load_dwordx4 v10, s[44:47], s33 offen lds
    s_waitcnt lgkmcnt(6)
    v_mfma_f32_16x16x32_bf16 v[24:27], v[56:59], v[164:167], v[24:27]
    ds_read_b64_tr_b16 v[72:73], v6 offset:4096
    v_mfma_f32_16x16x32_bf16 v[40:43], v[56:59], v[168:171], v[40:43]
    ds_read_b64_tr_b16 v[74:75], v6 offset:6144
    s_waitcnt lgkmcnt(6)
    v_mfma_f32_16x16x32_bf16 v[28:31], v[60:63], v[164:167], v[28:31]
    ds_read_b64_tr_b16 v[76:77], v7 offset:4096
    v_mfma_f32_16x16x32_bf16 v[44:47], v[60:63], v[168:171], v[44:47]
    ds_read_b64_tr_b16 v[78:79], v7 offset:6144
    s_waitcnt vmcnt(14)
    s_waitcnt lgkmcnt(6)
    v_mfma_f32_16x16x32_bf16 v[16:19], v[64:67], v[172:175], v[16:19]
    ds_read_b64_tr_b16 v[48:49], v4 offset:8192
    s_add_u32 m0, s61, 81920
    s_add_u32 s33, s100, 4
    s_and_b32 s33, s33, 7
    s_lshl_b32 s33, s33, 17
    s_add_u32 s33, s33, s60
    s_add_u32 s33, s33, 0x10000
    buffer_load_dwordx4 v10, s[44:47], s33 offen lds
    v_mfma_f32_16x16x32_bf16 v[32:35], v[64:67], v[176:179], v[32:35]
    ds_read_b64_tr_b16 v[50:51], v4 offset:10240
    s_waitcnt lgkmcnt(6)
    v_mfma_f32_16x16x32_bf16 v[20:23], v[68:71], v[172:175], v[20:23]
    ds_read_b64_tr_b16 v[52:53], v5 offset:8192
    v_mfma_f32_16x16x32_bf16 v[36:39], v[68:71], v[176:179], v[36:39]
    ds_read_b64_tr_b16 v[54:55], v5 offset:10240
    s_add_u32 m0, s61, 90112
    s_add_u32 s33, s100, 6
    s_and_b32 s33, s33, 7
    s_lshl_b32 s33, s33, 17
    s_add_u32 s33, s33, s60
    s_add_u32 s33, s33, 0x10000
    buffer_load_dwordx4 v10, s[44:47], s33 offen lds
    s_waitcnt lgkmcnt(6)
    v_mfma_f32_16x16x32_bf16 v[24:27], v[72:75], v[172:175], v[24:27]
    ds_read_b64_tr_b16 v[56:57], v6 offset:8192
    v_mfma_f32_16x16x32_bf16 v[40:43], v[72:75], v[176:179], v[40:43]
    ds_read_b64_tr_b16 v[58:59], v6 offset:10240
    s_waitcnt lgkmcnt(6)
    v_mfma_f32_16x16x32_bf16 v[28:31], v[76:79], v[172:175], v[28:31]
    ds_read_b64_tr_b16 v[60:61], v7 offset:8192
    v_mfma_f32_16x16x32_bf16 v[44:47], v[76:79], v[176:179], v[44:47]
    ds_read_b64_tr_b16 v[62:63], v7 offset:10240
    s_waitcnt vmcnt(14)
    s_waitcnt lgkmcnt(6)
    v_mfma_f32_16x16x32_bf16 v[16:19], v[48:51], v[180:183], v[16:19]
    ds_read_b64_tr_b16 v[64:65], v4 offset:12288
    s_add_u32 m0, s61, 98304
    s_add_u32 s33, s100, 8
    s_and_b32 s33, s33, 7
    s_lshl_b32 s33, s33, 17
    s_add_u32 s33, s33, s60
    s_add_u32 s33, s33, 0x110000
    buffer_load_dwordx4 v10, s[44:47], s33 offen lds
    v_mfma_f32_16x16x32_bf16 v[32:35], v[48:51], v[184:187], v[32:35]
    ds_read_b64_tr_b16 v[66:67], v4 offset:14336
    s_waitcnt lgkmcnt(6)
    v_mfma_f32_16x16x32_bf16 v[20:23], v[52:55], v[180:183], v[20:23]
    ds_read_b64_tr_b16 v[68:69], v5 offset:12288
    v_mfma_f32_16x16x32_bf16 v[36:39], v[52:55], v[184:187], v[36:39]
    ds_read_b64_tr_b16 v[70:71], v5 offset:14336
    s_add_u32 m0, s61, 106496
    s_add_u32 s33, s100, 10
    s_and_b32 s33, s33, 7
    s_lshl_b32 s33, s33, 17
    s_add_u32 s33, s33, s60
    s_add_u32 s33, s33, 0x110000
    buffer_load_dwordx4 v10, s[44:47], s33 offen lds
    s_waitcnt lgkmcnt(6)
    v_mfma_f32_16x16x32_bf16 v[24:27], v[56:59], v[180:183], v[24:27]
    ds_read_b64_tr_b16 v[72:73], v6 offset:12288
    v_mfma_f32_16x16x32_bf16 v[40:43], v[56:59], v[184:187], v[40:43]
    ds_read_b64_tr_b16 v[74:75], v6 offset:14336
    s_waitcnt lgkmcnt(6)
    v_mfma_f32_16x16x32_bf16 v[28:31], v[60:63], v[180:183], v[28:31]
    ds_read_b64_tr_b16 v[76:77], v7 offset:12288
    v_mfma_f32_16x16x32_bf16 v[44:47], v[60:63], v[184:187], v[44:47]
    ds_read_b64_tr_b16 v[78:79], v7 offset:14336
    s_waitcnt vmcnt(14)
    s_waitcnt lgkmcnt(6)
    v_mfma_f32_16x16x32_bf16 v[16:19], v[64:67], v[188:191], v[16:19]
    ds_read_b64_tr_b16 v[48:49], v4 offset:16384
    s_add_u32 m0, s61, 114688
    s_add_u32 s33, s100, 12
    s_and_b32 s33, s33, 7
    s_lshl_b32 s33, s33, 17
    s_add_u32 s33, s33, s60
    s_add_u32 s33, s33, 0x110000
    buffer_load_dwordx4 v10, s[44:47], s33 offen lds
    v_mfma_f32_16x16x32_bf16 v[32:35], v[64:67], v[192:195], v[32:35]
    ds_read_b64_tr_b16 v[50:51], v4 offset:18432
    s_waitcnt lgkmcnt(6)
    v_mfma_f32_16x16x32_bf16 v[20:23], v[68:71], v[188:191], v[20:23]
    ds_read_b64_tr_b16 v[52:53], v5 offset:16384
    v_mfma_f32_16x16x32_bf16 v[36:39], v[68:71], v[192:195], v[36:39]
    ds_read_b64_tr_b16 v[54:55], v5 offset:18432
    s_add_u32 m0, s61, 122880
    s_add_u32 s33, s100, 14
    s_and_b32 s33, s33, 7
    s_lshl_b32 s33, s33, 17
    s_add_u32 s33, s33, s60
    s_add_u32 s33, s33, 0x110000
    buffer_load_dwordx4 v10, s[44:47], s33 offen lds
    s_waitcnt lgkmcnt(6)
    v_mfma_f32_16x16x32_bf16 v[24:27], v[72:75], v[188:191], v[24:27]
    ds_read_b64_tr_b16 v[56:57], v6 offset:16384
    v_mfma_f32_16x16x32_bf16 v[40:43], v[72:75], v[192:195], v[40:43]
    ds_read_b64_tr_b16 v[58:59], v6 offset:18432
    s_waitcnt lgkmcnt(6)
    v_mfma_f32_16x16x32_bf16 v[28:31], v[76:79], v[188:191], v[28:31]
    ds_read_b64_tr_b16 v[60:61], v7 offset:16384
    v_mfma_f32_16x16x32_bf16 v[44:47], v[76:79], v[192:195], v[44:47]
    ds_read_b64_tr_b16 v[62:63], v7 offset:18432
    s_cmp_lg_u32 s24, 0
    s_cbranch_scc1 L_NOPOLL
    s_mov_b32 s35, 200000
L_PC1:
    buffer_load_dword v2, v15, s[20:23], s96 offen sc1
    s_waitcnt vmcnt(0)
    v_cmp_ne_u32 vcc, 1, v2
    s_cmp_eq_u64 vcc, 0
    s_cbranch_scc1 L_PC1_ok
    s_sub_u32 s35, s35, 1
    s_cmp_lg_u32 s35, 0
    s_cbranch_scc1 L_PC1
L_PC1_ok:
L_NOPOLL:
    s_waitcnt vmcnt(8)
    s_barrier
    s_waitcnt lgkmcnt(6)
    v_mfma_f32_16x16x32_bf16 v[16:19], v[48:51], v[196:199], v[16:19]
    ds_read_b64_tr_b16 v[64:65], v4 offset:20480
    s_add_u32 s34, s101, 0
    s_and_b32 s34, s34, 7
    s_lshl_b32 s34, s34, 11
    s_add_u32 s33, s97, s34
    buffer_load_dwordx4 v[96:99], v1, s[20:23], s33 offen offset:1024 sc1
    s_add_u32 s33, s98, s34
    buffer_load_dwordx4 v[100:103], v1, s[20:23], s33 offen offset:1024 sc1
    v_mfma_f32_16x16x32_bf16 v[32:35], v[48:51], v[200:203], v[32:35]
    ds_read_b64_tr_b16 v[66:67], v4 offset:22528
    s_waitcnt lgkmcnt(6)
    v_mfma_f32_16x16x32_bf16 v[20:23], v[52:55], v[196:199], v[20:23]
    ds_read_b64_tr_b16 v[68:69], v5 offset:20480
    v_mfma_f32_16x16x32_bf16 v[36:39], v[52:55], v[200:203], v[36:39]
    ds_read_b64_tr_b16 v[70:71], v5 offset:22528
    s_add_u32 s34, s101, 1
    s_and_b32 s34, s34, 7
    s_lshl_b32 s34, s34, 11
    s_add_u32 s33, s97, s34
    buffer_load_dwordx4 v[104:107], v1, s[20:23], s33 offen offset:1024 sc1
    s_add_u32 s33, s98, s34
    buffer_load_dwordx4 v[108:111], v1, s[20:23], s33 offen offset:1024 sc1
    s_waitcnt lgkmcnt(6)
    v_mfma_f32_16x16x32_bf16 v[24:27], v[56:59], v[196:199], v[24:27]
    ds_read_b64_tr_b16 v[72:73], v6 offset:20480
    v_mfma_f32_16x16x32_bf16 v[40:43], v[56:59], v[200:203], v[40:43]
    ds_read_b64_tr_b16 v[74:75], v6 offset:22528
    s_waitcnt lgkmcnt(6)
    v_mfma_f32_16x16x32_bf16 v[28:31], v[60:63], v[196:199], v[28:31]
    ds_read_b64_tr_b16 v[76:77], v7 offset:20480
    v_mfma_f32_16x16x32_bf16 v[44:47], v[60:63], v[200:203], v[44:47]
    ds_read_b64_tr_b16 v[78:79], v7 offset:22528
    s_waitcnt lgkmcnt(6)
    v_mfma_f32_16x16x32_bf16 v[16:19], v[64:67], v[204:207], v[16:19]
    ds_read_b64_tr_b16 v[48:49], v4 offset:24576
    s_add_u32 s34, s101, 2
    s_and_b32 s34, s34, 7
    s_lshl_b32 s34, s34, 11
    s_add_u32 s33, s97, s34
    buffer_load_dwordx4 v[112:115], v1, s[20:23], s33 offen offset:1024 sc1
    s_add_u32 s33, s98, s34
    buffer_load_dwordx4 v[116:119], v1, s[20:23], s33 offen offset:1024 sc1
    v_mfma_f32_16x16x32_bf16 v[32:35], v[64:67], v[208:211], v[32:35]
    ds_read_b64_tr_b16 v[50:51], v4 offset:26624
    s_waitcnt lgkmcnt(6)
    v_mfma_f32_16x16x32_bf16 v[20:23], v[68:71], v[204:207], v[20:23]
    ds_read_b64_tr_b16 v[52:53], v5 offset:24576
    v_mfma_f32_16x16x32_bf16 v[36:39], v[68:71], v[208:211], v[36:39]
    ds_read_b64_tr_b16 v[54:55], v5 offset:26624
    s_add_u32 s34, s101, 3
    s_and_b32 s34, s34, 7
    s_lshl_b32 s34, s34, 11
    s_add_u32 s33, s97, s34
    buffer_load_dwordx4 v[120:123], v1, s[20:23], s33 offen offset:1024 sc1
    s_add_u32 s33, s98, s34
    buffer_load_dwordx4 v[124:127], v1, s[20:23], s33 offen offset:1024 sc1
    s_waitcnt lgkmcnt(6)
    v_mfma_f32_16x16x32_bf16 v[24:27], v[72:75], v[204:207], v[24:27]
    ds_read_b64_tr_b16 v[56:57], v6 offset:24576
    v_mfma_f32_16x16x32_bf16 v[40:43], v[72:75], v[208:211], v[40:43]
    ds_read_b64_tr_b16 v[58:59], v6 offset:26624
    s_waitcnt lgkmcnt(6)
    v_mfma_f32_16x16x32_bf16 v[28:31], v[76:79], v[204:207], v[28:31]
    ds_read_b64_tr_b16 v[60:61], v7 offset:24576
    v_mfma_f32_16x16x32_bf16 v[44:47], v[76:79], v[208:211], v[44:47]
    ds_read_b64_tr_b16 v[62:63], v7 offset:26624
    s_waitcnt lgkmcnt(6)
    v_mfma_f32_16x16x32_bf16 v[16:19], v[48:51], v[212:215], v[16:19]
    ds_read_b64_tr_b16 v[64:65], v4 offset:28672
    s_add_u32 s34, s101, 4
    s_and_b32 s34, s34, 7
    s_lshl_b32 s34, s34, 11
    s_add_u32 s33, s97, s34
    buffer_load_dwordx4 v[128:131], v1, s[20:23], s33 offen offset:1024 sc1
    s_add_u32 s33, s98, s34
    buffer_load_dwordx4 v[132:135], v1, s[20:23], s33 offen offset:1024 sc1
    v_mfma_f32_16x16x32_bf16 v[32:35], v[48:51], v[216:219], v[32:35]
    ds_read_b64_tr_b16 v[66:67], v4 offset:30720
    s_waitcnt lgkmcnt(6)
    v_mfma_f32_16x16x32_bf16 v[20:23], v[52:55], v[212:215], v[20:23]
    ds_read_b64_tr_b16 v[68:69], v5 offset:28672
    v_mfma_f32_16x16x32_bf16 v[36:39], v[52:55], v[216:219], v[36:39]
    ds_read_b64_tr_b16 v[70:71], v5 offset:30720
    s_add_u32 s34, s101, 5
    s_and_b32 s34, s34, 7
    s_lshl_b32 s34, s34, 11
    s_add_u32 s33, s97, s34
    buffer_load_dwordx4 v[136:139], v1, s[20:23], s33 offen offset:1024 sc1
    s_add_u32 s33, s98, s34
    buffer_load_dwordx4 v[140:143], v1, s[20:23], s33 offen offset:1024 sc1
    s_waitcnt lgkmcnt(6)
    v_mfma_f32_16x16x32_bf16 v[24:27], v[56:59], v[212:215], v[24:27]
    ds_read_b64_tr_b16 v[72:73], v6 offset:28672
    v_mfma_f32_16x16x32_bf16 v[40:43], v[56:59], v[216:219], v[40:43]
    ds_read_b64_tr_b16 v[74:75], v6 offset:30720
    s_waitcnt lgkmcnt(6)
    v_mfma_f32_16x16x32_bf16 v[28:31], v[60:63], v[212:215], v[28:31]
    ds_read_b64_tr_b16 v[76:77], v7 offset:28672
    v_mfma_f32_16x16x32_bf16 v[44:47], v[60:63], v[216:219], v[44:47]
    ds_read_b64_tr_b16 v[78:79], v7 offset:30720
    s_waitcnt lgkmcnt(6)
    v_mfma_f32_16x16x32_bf16 v[16:19], v[64:67], v[220:223], v[16:19]
    s_add_u32 s34, s101, 6
    s_and_b32 s34, s34, 7
    s_lshl_b32 s34, s34, 11
    s_add_u32 s33, s97, s34
    buffer_load_dwordx4 v[144:147], v1, s[20:23], s33 offen offset:1024 sc1
    s_add_u32 s33, s98, s34
    buffer_load_dwordx4 v[148:151], v1, s[20:23], s33 offen offset:1024 sc1
    v_mfma_f32_16x16x32_bf16 v[32:35], v[64:67], v[224:227], v[32:35]
    s_waitcnt lgkmcnt(4)
    v_mfma_f32_16x16x32_bf16 v[20:23], v[68:71], v[220:223], v[20:23]
    v_mfma_f32_16x16x32_bf16 v[36:39], v[68:71], v[224:227], v[36:39]
    s_add_u32 s34, s101, 7
    s_and_b32 s34, s34, 7
    s_lshl_b32 s34, s34, 11
    s_add_u32 s33, s97, s34
    buffer_load_dwordx4 v[152:155], v1, s[20:23], s33 offen offset:1024 sc1
    s_add_u32 s33, s98, s34
    buffer_load_dwordx4 v[156:159], v1, s[20:23], s33 offen offset:1024 sc1
    s_waitcnt lgkmcnt(2)
    v_mfma_f32_16x16x32_bf16 v[24:27], v[72:75], v[220:223], v[24:27]
    v_mfma_f32_16x16x32_bf16 v[40:43], v[72:75], v[224:227], v[40:43]
    s_waitcnt lgkmcnt(0)
    v_mfma_f32_16x16x32_bf16 v[28:31], v[76:79], v[220:223], v[28:31]
    v_mfma_f32_16x16x32_bf16 v[44:47], v[76:79], v[224:227], v[44:47]
    s_waitcnt vmcnt(16)
    s_barrier
    ds_read_b64_tr_b16 v[48:49], v8 offset:0
    ds_read_b64_tr_b16 v[50:51], v8 offset:2048
    ds_read_b64_tr_b16 v[52:53], v9 offset:0
    ds_read_b64_tr_b16 v[54:55], v9 offset:2048
    ds_read_b64_tr_b16 v[56:57], v11 offset:0
    ds_read_b64_tr_b16 v[58:59], v11 offset:2048
    ds_read_b64_tr_b16 v[60:61], v14 offset:0
    ds_read_b64_tr_b16 v[62:63], v14 offset:2048
    s_waitcnt vmcnt(14)
    s_waitcnt lgkmcnt(6)
    v_mfma_f32_16x16x32_bf16 v[16:19], v[48:51], v[96:99], v[16:19]
    ds_read_b64_tr_b16 v[64:65], v8 offset:4096
    v_mfma_f32_16x16x32_bf16 v[32:35], v[48:51], v[100:103], v[32:35]
    ds_read_b64_tr_b16 v[66:67], v8 offset:6144
    s_waitcnt lgkmcnt(6)
    v_mfma_f32_16x16x32_bf16 v[20:23], v[52:55], v[96:99], v[20:23]
    ds_read_b64_tr_b16 v[68:69], v9 offset:4096
    v_mfma_f32_16x16x32_bf16 v[36:39], v[52:55], v[100:103], v[36:39]
    ds_read_b64_tr_b16 v[70:71], v9 offset:6144
    s_waitcnt lgkmcnt(6)
    v_mfma_f32_16x16x32_bf16 v[24:27], v[56:59], v[96:99], v[24:27]
    ds_read_b64_tr_b16 v[72:73], v11 offset:4096
    v_mfma_f32_16x16x32_bf16 v[40:43], v[56:59], v[100:103], v[40:43]
    ds_read_b64_tr_b16 v[74:75], v11 offset:6144
    s_waitcnt lgkmcnt(6)
    v_mfma_f32_16x16x32_bf16 v[28:31], v[60:63], v[96:99], v[28:31]
    ds_read_b64_tr_b16 v[76:77], v14 offset:4096
    v_mfma_f32_16x16x32_bf16 v[44:47], v[60:63], v[100:103], v[44:47]
    ds_read_b64_tr_b16 v[78:79], v14 offset:6144
    s_waitcnt vmcnt(12)
    s_waitcnt lgkmcnt(6)
    v_mfma_f32_16x16x32_bf16 v[16:19], v[64:67], v[104:107], v[16:19]
    ds_read_b64_tr_b16 v[48:49], v8 offset:8192
    v_mfma_f32_16x16x32_bf16 v[32:35], v[64:67], v[108:111], v[32:35]
    ds_read_b64_tr_b16 v[50:51], v8 offset:10240
    s_waitcnt lgkmcnt(6)
    v_mfma_f32_16x16x32_bf16 v[20:23], v[68:71], v[104:107], v[20:23]
    ds_read_b64_tr_b16 v[52:53], v9 offset:8192
    v_mfma_f32_16x16x32_bf16 v[36:39], v[68:71], v[108:111], v[36:39]
    ds_read_b64_tr_b16 v[54:55], v9 offset:10240
    s_waitcnt lgkmcnt(6)
    v_mfma_f32_16x16x32_bf16 v[24:27], v[72:75], v[104:107], v[24:27]
    ds_read_b64_tr_b16 v[56:57], v11 offset:8192
    v_mfma_f32_16x16x32_bf16 v[40:43], v[72:75], v[108:111], v[40:43]
    ds_read_b64_tr_b16 v[58:59], v11 offset:10240
    s_waitcnt lgkmcnt(6)
    v_mfma_f32_16x16x32_bf16 v[28:31], v[76:79], v[104:107], v[28:31]
    ds_read_b64_tr_b16 v[60:61], v14 offset:8192
    v_mfma_f32_16x16x32_bf16 v[44:47], v[76:79], v[108:111], v[44:47]
    ds_read_b64_tr_b16 v[62:63], v14 offset:10240
    s_waitcnt vmcnt(10)
    s_waitcnt lgkmcnt(6)
    v_mfma_f32_16x16x32_bf16 v[16:19], v[48:51], v[112:115], v[16:19]
    ds_read_b64_tr_b16 v[64:65], v8 offset:12288
    v_mfma_f32_16x16x32_bf16 v[32:35], v[48:51], v[116:119], v[32:35]
    ds_read_b64_tr_b16 v[66:67], v8 offset:14336
    s_waitcnt lgkmcnt(6)
    v_mfma_f32_16x16x32_bf16 v[20:23], v[52:55], v[112:115], v[20:23]
    ds_read_b64_tr_b16 v[68:69], v9 offset:12288
    v_mfma_f32_16x16x32_bf16 v[36:39], v[52:55], v[116:119], v[36:39]
    ds_read_b64_tr_b16 v[70:71], v9 offset:14336
    s_waitcnt lgkmcnt(6)
    v_mfma_f32_16x16x32_bf16 v[24:27], v[56:59], v[112:115], v[24:27]
    ds_read_b64_tr_b16 v[72:73], v11 offset:12288
    v_mfma_f32_16x16x32_bf16 v[40:43], v[56:59], v[116:119], v[40:43]
    ds_read_b64_tr_b16 v[74:75], v11 offset:14336
    s_waitcnt lgkmcnt(6)
    v_mfma_f32_16x16x32_bf16 v[28:31], v[60:63], v[112:115], v[28:31]
    ds_read_b64_tr_b16 v[76:77], v14 offset:12288
    v_mfma_f32_16x16x32_bf16 v[44:47], v[60:63], v[116:119], v[44:47]
    ds_read_b64_tr_b16 v[78:79], v14 offset:14336
    s_waitcnt vmcnt(8)
    s_waitcnt lgkmcnt(6)
    v_mfma_f32_16x16x32_bf16 v[16:19], v[64:67], v[120:123], v[16:19]
    ds_read_b64_tr_b16 v[48:49], v8 offset:16384
    v_mfma_f32_16x16x32_bf16 v[32:35], v[64:67], v[124:127], v[32:35]
    ds_read_b64_tr_b16 v[50:51], v8 offset:18432
    s_waitcnt lgkmcnt(6)
    v_mfma_f32_16x16x32_bf16 v[20:23], v[68:71], v[120:123], v[20:23]
    ds_read_b64_tr_b16 v[52:53], v9 offset:16384
    v_mfma_f32_16x16x32_bf16 v[36:39], v[68:71], v[124:127], v[36:39]
    ds_read_b64_tr_b16 v[54:55], v9 offset:18432
    s_waitcnt lgkmcnt(6)
    v_mfma_f32_16x16x32_bf16 v[24:27], v[72:75], v[120:123], v[24:27]
    ds_read_b64_tr_b16 v[56:57], v11 offset:16384
    v_mfma_f32_16x16x32_bf16 v[40:43], v[72:75], v[124:127], v[40:43]
    ds_read_b64_tr_b16 v[58:59], v11 offset:18432
    s_waitcnt lgkmcnt(6)
    v_mfma_f32_16x16x32_bf16 v[28:31], v[76:79], v[120:123], v[28:31]
    ds_read_b64_tr_b16 v[60:61], v14 offset:16384
    v_mfma_f32_16x16x32_bf16 v[44:47], v[76:79], v[124:127], v[44:47]
    ds_read_b64_tr_b16 v[62:63], v14 offset:18432
    s_waitcnt vmcnt(6)
    s_waitcnt lgkmcnt(6)
    v_mfma_f32_16x16x32_bf16 v[16:19], v[48:51], v[128:131], v[16:19]
    ds_read_b64_tr_b16 v[64:65], v8 offset:20480
    v_mfma_f32_16x16x32_bf16 v[32:35], v[48:51], v[132:135], v[32:35]
    ds_read_b64_tr_b16 v[66:67], v8 offset:22528
    s_waitcnt lgkmcnt(6)
    v_mfma_f32_16x16x32_bf16 v[20:23], v[52:55], v[128:131], v[20:23]
    ds_read_b64_tr_b16 v[68:69], v9 offset:20480
    v_mfma_f32_16x16x32_bf16 v[36:39], v[52:55], v[132:135], v[36:39]
    ds_read_b64_tr_b16 v[70:71], v9 offset:22528
    s_waitcnt lgkmcnt(6)
    v_mfma_f32_16x16x32_bf16 v[24:27], v[56:59], v[128:131], v[24:27]
    ds_read_b64_tr_b16 v[72:73], v11 offset:20480
    v_mfma_f32_16x16x32_bf16 v[40:43], v[56:59], v[132:135], v[40:43]
    ds_read_b64_tr_b16 v[74:75], v11 offset:22528
    s_waitcnt lgkmcnt(6)
    v_mfma_f32_16x16x32_bf16 v[28:31], v[60:63], v[128:131], v[28:31]
    ds_read_b64_tr_b16 v[76:77], v14 offset:20480
    v_mfma_f32_16x16x32_bf16 v[44:47], v[60:63], v[132:135], v[44:47]
    ds_read_b64_tr_b16 v[78:79], v14 offset:22528
    s_waitcnt vmcnt(4)
    s_waitcnt lgkmcnt(6)
    v_mfma_f32_16x16x32_bf16 v[16:19], v[64:67], v[136:139], v[16:19]
    ds_read_b64_tr_b16 v[48:49], v8 offset:24576
    v_mfma_f32_16x16x32_bf16 v[32:35], v[64:67], v[140:143], v[32:35]
    ds_read_b64_tr_b16 v[50:51], v8 offset:26624
    s_waitcnt lgkmcnt(6)
    v_mfma_f32_16x16x32_bf16 v[20:23], v[68:71], v[136:139], v[20:23]
    ds_read_b64_tr_b16 v[52:53], v9 offset:24576
    v_mfma_f32_16x16x32_bf16 v[36:39], v[68:71], v[140:143], v[36:39]
    ds_read_b64_tr_b16 v[54:55], v9 offset:26624
    s_waitcnt lgkmcnt(6)
    v_mfma_f32_16x16x32_bf16 v[24:27], v[72:75], v[136:139], v[24:27]
    ds_read_b64_tr_b16 v[56:57], v11 offset:24576
    v_mfma_f32_16x16x32_bf16 v[40:43], v[72:75], v[140:143], v[40:43]
    ds_read_b64_tr_b16 v[58:59], v11 offset:26624
    s_waitcnt lgkmcnt(6)
    v_mfma_f32_16x16x32_bf16 v[28:31], v[76:79], v[136:139], v[28:31]
    ds_read_b64_tr_b16 v[60:61], v14 offset:24576
    v_mfma_f32_16x16x32_bf16 v[44:47], v[76:79], v[140:143], v[44:47]
    ds_read_b64_tr_b16 v[62:63], v14 offset:26624
    s_waitcnt vmcnt(2)
    s_waitcnt lgkmcnt(6)
    v_mfma_f32_16x16x32_bf16 v[16:19], v[48:51], v[144:147], v[16:19]
    ds_read_b64_tr_b16 v[64:65], v8 offset:28672
    v_mfma_f32_16x16x32_bf16 v[32:35], v[48:51], v[148:151], v[32:35]
    ds_read_b64_tr_b16 v[66:67], v8 offset:30720
    s_waitcnt lgkmcnt(6)
    v_mfma_f32_16x16x32_bf16 v[20:23], v[52:55], v[144:147], v[20:23]
    ds_read_b64_tr_b16 v[68:69], v9 offset:28672
    v_mfma_f32_16x16x32_bf16 v[36:39], v[52:55], v[148:151], v[36:39]
    ds_read_b64_tr_b16 v[70:71], v9 offset:30720
    s_waitcnt lgkmcnt(6)
    v_mfma_f32_16x16x32_bf16 v[24:27], v[56:59], v[144:147], v[24:27]
    ds_read_b64_tr_b16 v[72:73], v11 offset:28672
    v_mfma_f32_16x16x32_bf16 v[40:43], v[56:59], v[148:151], v[40:43]
    ds_read_b64_tr_b16 v[74:75], v11 offset:30720
    s_waitcnt lgkmcnt(6)
    v_mfma_f32_16x16x32_bf16 v[28:31], v[60:63], v[144:147], v[28:31]
    ds_read_b64_tr_b16 v[76:77], v14 offset:28672
    v_mfma_f32_16x16x32_bf16 v[44:47], v[60:63], v[148:151], v[44:47]
    ds_read_b64_tr_b16 v[78:79], v14 offset:30720
    s_waitcnt vmcnt(0)
    s_waitcnt lgkmcnt(6)
    v_mfma_f32_16x16x32_bf16 v[16:19], v[64:67], v[152:155], v[16:19]
    v_mfma_f32_16x16x32_bf16 v[32:35], v[64:67], v[156:159], v[32:35]
    s_waitcnt lgkmcnt(4)
    v_mfma_f32_16x16x32_bf16 v[20:23], v[68:71], v[152:155], v[20:23]
    v_mfma_f32_16x16x32_bf16 v[36:39], v[68:71], v[156:159], v[36:39]
    s_waitcnt lgkmcnt(2)
    v_mfma_f32_16x16x32_bf16 v[24:27], v[72:75], v[152:155], v[24:27]
    v_mfma_f32_16x16x32_bf16 v[40:43], v[72:75], v[156:159], v[40:43]
    s_waitcnt lgkmcnt(0)
    v_mfma_f32_16x16x32_bf16 v[28:31], v[76:79], v[152:155], v[28:31]
    v_mfma_f32_16x16x32_bf16 v[44:47], v[76:79], v[156:159], v[44:47]
    s_lshl_b32 s33, s24, 12
    s_add_u32 s33, s33, 0x20000
    v_add_u32 v2, s33, v1
    v_xor_b32 v3, 0x4000, v2
    v_lshlrev_b32 v12, 11, v12
    v_and_b32 v15, 1, v13
    v_lshlrev_b32 v15, 5, v15
    v_lshrrev_b32 v13, 1, v13
    v_lshlrev_b32 v13, 4, v13
    v_add3_u32 v12, v12, v15, v13
    s_lshl_b32 s32, s32, 15
    s_lshl_b32 s33, s57, 7
    s_add_u32 s32, s32, s33
    ds_write_b128 v2, v[32:35] offset:0
    ds_write_b128 v2, v[36:39] offset:1024
    ds_write_b128 v2, v[40:43] offset:2048
    ds_write_b128 v2, v[44:47] offset:3072
    s_waitcnt lgkmcnt(0)
    s_barrier
    ds_read_b128 v[96:99], v3 offset:0
    ds_read_b128 v[100:103], v3 offset:1024
    ds_read_b128 v[104:107], v3 offset:2048
    ds_read_b128 v[108:111], v3 offset:3072
    s_waitcnt lgkmcnt(3)
    v_pk_add_f32 v[16:17], v[16:17], v[96:97]
    v_pk_add_f32 v[18:19], v[18:19], v[98:99]
    v_cvt_pk_bf16_f32 v48, v16, v17
    v_cvt_pk_bf16_f32 v49, v18, v19
    s_waitcnt lgkmcnt(2)
    v_pk_add_f32 v[20:21], v[20:21], v[100:101]
    v_pk_add_f32 v[22:23], v[22:23], v[102:103]
    v_cvt_pk_bf16_f32 v50, v20, v21
    v_cvt_pk_bf16_f32 v51, v22, v23
    s_nop 0
    v_permlane16_swap_b32 v48, v50
    v_permlane16_swap_b32 v49, v51
    buffer_store_dwordx4 v[48:51], v12, s[48:51], s32 offen offset:0
    s_waitcnt lgkmcnt(1)
    v_pk_add_f32 v[24:25], v[24:25], v[104:105]
    v_pk_add_f32 v[26:27], v[26:27], v[106:107]
    v_cvt_pk_bf16_f32 v52, v24, v25
    v_cvt_pk_bf16_f32 v53, v26, v27
    s_waitcnt lgkmcnt(0)
    v_pk_add_f32 v[28:29], v[28:29], v[108:109]
    v_pk_add_f32 v[30:31], v[30:31], v[110:111]
    v_cvt_pk_bf16_f32 v54, v28, v29
    v_cvt_pk_bf16_f32 v55, v30, v31
    s_nop 0
    v_permlane16_swap_b32 v52, v54
    v_permlane16_swap_b32 v53, v55
    buffer_store_dwordx4 v[52:55], v12, s[48:51], s32 offen offset:64
    s_endpgm
L_OOL2:
    s_waitcnt vmcnt(0)
    s_mov_b64 exec, 1
    v_mov_b32 v2, 1
    v_mov_b32 v3, 0xfc00
    ds_add_rtn_u32 v3, v3, v2
    s_waitcnt lgkmcnt(0)
    v_readfirstlane_b32 s33, v3
    s_cmp_lg_u32 s33, 7
    s_cbranch_scc1 L_NOSIG0
    v_mov_b32 v3, 0
    buffer_store_dword v2, v3, s[20:23], s39 offen sc1
L_NOSIG0:
    s_mov_b64 exec, -1
    s_add_u32 s39, s39, 128
    s_branch L_OOLR2
L_CTR1:
    s_nop 3
    v_mov_b32 v48, 0
    v_mov_b32 v49, 0
    v_mov_b32 v50, 0
    v_mov_b32 v51, 0
    s_nop 1
    s_branch L_CT1
L_CTR2:
    s_nop 3
    v_mov_b32 v48, 0
    v_mov_b32 v49, 0
    v_mov_b32 v50, 0
    v_mov_b32 v51, 0
    s_nop 1
    s_branch L_CT2
L_CTR3:
    s_nop 3
    v_mov_b32 v48, 0
    v_mov_b32 v49, 0
    v_mov_b32 v50, 0
    v_mov_b32 v51, 0
    s_nop 1
    s_branch L_CT3
L_CTR4:
    s_nop 3
    v_mov_b32 v48, 0
    v_mov_b32 v49, 0
    v_mov_b32 v50, 0
    v_mov_b32 v51, 0
    s_nop 1
    s_branch L_CT4
L_CTR5:
    s_nop 3
    v_mov_b32 v48, 0
    v_mov_b32 v49, 0
    v_mov_b32 v50, 0
    v_mov_b32 v51, 0
    s_nop 1
    s_branch L_CT5
L_CTR6:
    s_nop 3
    v_mov_b32 v48, 0
    v_mov_b32 v49, 0
    v_mov_b32 v50, 0
    v_mov_b32 v51, 0
    s_nop 1
    s_branch L_CT6
L_CTR7:
    s_nop 3
    v_mov_b32 v48, 0
    v_mov_b32 v49, 0
    v_mov_b32 v50, 0
    v_mov_b32 v51, 0
    s_nop 1
    s_branch L_CT7
L_CTR8:
    s_nop 3
    v_mov_b32 v48, 0
    v_mov_b32 v49, 0
    v_mov_b32 v50, 0
    v_mov_b32 v51, 0
    s_nop 1
    s_branch L_CT8
L_CTR9:
    s_nop 3
    v_mov_b32 v48, 0
    v_mov_b32 v49, 0
    v_mov_b32 v50, 0
    v_mov_b32 v51, 0
    s_nop 1
    s_branch L_CT9
L_CTR10:
    s_nop 3
    v_mov_b32 v48, 0
    v_mov_b32 v49, 0
    v_mov_b32 v50, 0
    v_mov_b32 v51, 0
    s_nop 1
    s_branch L_CT10
L_CTR11:
    s_nop 3
    v_mov_b32 v48, 0
    v_mov_b32 v49, 0
    v_mov_b32 v50, 0
    v_mov_b32 v51, 0
    s_nop 1
    s_branch L_CT11
L_CTR12:
    s_nop 3
    v_mov_b32 v48, 0
    v_mov_b32 v49, 0
    v_mov_b32 v50, 0
    v_mov_b32 v51, 0
    s_nop 1
    s_branch L_CT12
L_CTR13:
    s_nop 3
    v_mov_b32 v48, 0
    v_mov_b32 v49, 0
    v_mov_b32 v50, 0
    v_mov_b32 v51, 0
    s_nop 1
    s_branch L_CT13
L_CTR14:
    s_nop 3
    v_mov_b32 v48, 0
    v_mov_b32 v49, 0
    v_mov_b32 v50, 0
    v_mov_b32 v51, 0
    s_nop 1
    s_branch L_CT14
L_CTR15:
    s_nop 3
    v_mov_b32 v48, 0
    v_mov_b32 v49, 0
    v_mov_b32 v50, 0
    v_mov_b32 v51, 0
    s_nop 1
    s_branch L_CT15
L_END:
    s_endpgm
.section .rodata,"a"
.p2align 6
.amdhsa_kernel standalone__sliding_block__prompt_kernel
  .amdhsa_next_free_vgpr 240
  .amdhsa_next_free_sgpr 102
  .amdhsa_accum_offset 240
  .amdhsa_group_segment_fixed_size 0
  .amdhsa_kernarg_size 48
  .amdhsa_user_sgpr_count 2
  .amdhsa_user_sgpr_kernarg_segment_ptr 1
  .amdhsa_system_sgpr_workgroup_id_x 1
.end_amdhsa_kernel
```
